```python
import torch

def _softmax(x, axis=-1):
    return torch.softmax(x, dim=axis)

def _gelu(x):
    return torch.nn.functional.gelu(x, approximate='tanh')

def _silu(x):
    return torch.nn.functional.silu(x)

def _sigmoid(x):
    return torch.sigmoid(x)

def _layernorm(x, axis=-1, eps=1e-05):
    m = x.mean(dim=axis, keepdim=True)
    v = x.var(dim=axis, keepdim=True, unbiased=False)
    return (x - m) / torch.sqrt(v + eps)

def _scatter_add(tgt, idx, src, axis=0):
    return tgt.clone().index_add_(axis, idx, src)

def _segment_sum(src, seg, n):
    out = torch.zeros((n,) + src.shape[1:], dtype=src.dtype)
    return out.index_add_(0, seg, src)

def _pad(x, pw):
    flat = tuple((v for pair in reversed(pw) for v in pair))
    return torch.nn.functional.pad(x, flat)
kernel_name = 'parallel_sum__linear_kernel_hedgehog__mixer_gmlp__prompt'

def setup_inputs():

    _w = lambda a: (lambda t: t.to(torch.bfloat16) if t.is_floating_point() else t)(torch.as_tensor(a))

    def _A_setup():
        B, S, D, H = (1, 2048, 512, 32)
        Dh = D // H
        return {'x': _w((lambda *s: torch.randn(*s, dtype=torch.bfloat16) * 0.05)(B, S, D)), 'wqkv': _w((lambda *s: torch.randn(*s, dtype=torch.bfloat16) * 0.8)(D, 3 * D)), 'w_phi': _w((lambda *s: torch.randn(*s, dtype=torch.bfloat16) * 0.8)(H, Dh, Dh) * Dh ** (-0.5)), 'wo': _w((lambda *s: torch.randn(*s, dtype=torch.bfloat16) * 0.1)(D, D))}
    _A_in = _A_setup()

    def _B_setup():
        B, S, D, F = (1, 2048, 512, 1376)
        Fh = F // 2
        return {'x': _w((lambda *s: torch.randn(*s, dtype=torch.bfloat16) * 0.05)(B, S, D)), 'w_in': _w((lambda *s: torch.randn(*s, dtype=torch.bfloat16) * 0.4)(D, 2 * Fh)), 'w_sp': _w(0.01 * (lambda *s: torch.randn(*s, dtype=torch.bfloat16) * 0.4)(S, S)), 'b_sp': _w(1.0 + 0.01 * (lambda *s: torch.randn(*s, dtype=torch.bfloat16) * 0.05)(S)), 'w_out': _w((lambda *s: torch.randn(*s, dtype=torch.bfloat16) * 0.05)(Fh, D))}
    _B_in = _B_setup()
    return {'A_x': _A_in['x'], 'A_wqkv': _A_in['wqkv'], 'A_w_phi': _A_in['w_phi'], 'A_wo': _A_in['wo'], 'B_x': _B_in['x'], 'B_w_in': _B_in['w_in'], 'B_w_sp': _B_in['w_sp'], 'B_b_sp': _B_in['b_sp'], 'B_w_out': _B_in['w_out']}

def reference(A_x, A_wqkv, A_w_phi, A_wo, B_x, B_w_in, B_w_sp, B_b_sp, B_w_out):

    def _A_ref(x, wqkv, w_phi, wo):
        B, S, D = x.shape
        H = 32
        Dh = D // H
        qkv = (lambda x, *d: x.permute(*d))((x @ wqkv).reshape(B, S, 3, H, Dh), 2, 0, 3, 1, 4)
        q, k, v = (qkv[0], qkv[1], qkv[2])
        pq = torch.einsum('bhsd,hdf->bhsf', q, w_phi)
        pk = torch.einsum('bhsd,hdf->bhsf', k, w_phi)
        phi_q = torch.concatenate([_softmax(pq, axis=-1), _softmax(-pq, axis=-1)], axis=-1)
        phi_k = torch.concatenate([_softmax(pk, axis=-1), _softmax(-pk, axis=-1)], axis=-1)
        kv = torch.einsum('bhsf,bhsd->bhfd', phi_k, v)
        z = torch.einsum('bhsf->bhf', phi_k)
        num = torch.einsum('bhqf,bhfd->bhqd', phi_q, kv)
        den = torch.einsum('bhqf,bhf->bhq', phi_q, z)[..., None] + 1e-06
        o = num / den
        return (lambda x, *d: x.permute(*d))(o, 0, 2, 1, 3).reshape(B, S, D) @ wo

    def _B_ref(x, w_in, w_sp, b_sp, w_out):
        B, S, D = x.shape
        F = w_in.shape[-1]
        Fh = F // 2
        z = _gelu(torch.einsum('bsd,df->bsf', x, w_in))
        z1 = z[..., :Fh].clone()
        z2 = _layernorm(z[..., Fh:], axis=-1)
        g = torch.einsum('ts,bsf->btf', w_sp, z2) + b_sp[None, :, None]
        return torch.einsum('bsf,fd->bsd', z1 * g, w_out)
    x = A_x
    xn = _layernorm(x, axis=-1)
    return x + _A_ref(xn, A_wqkv, A_w_phi, A_wo) + _B_ref(xn, B_w_in, B_w_sp, B_b_sp, B_w_out)
```

```asm
; @launch kernel=k1_kernel grid=(256,1,1) block=(768,1,1) lds=122880
; @launch kernel=k2_kernel grid=(128,1,1) block=(256,1,1) lds=8192
; @launch kernel=k3_kernel grid=(512,1,1) block=(512,1,1) lds=81920
; @launch kernel=k4_kernel grid=(256,1,1) block=(512,1,1) lds=98304
.amdgcn_target "amdgcn-amd-amdhsa--gfx950"
.text
.globl k1_kernel
.p2align 8
.type k1_kernel,@function
k1_kernel:
    s_cmp_ge_u32 s2, 256
    s_cbranch_scc1 L_k1_end
    s_load_dwordx2 s[4:5], s[0:1], 0
    s_load_dwordx2 s[6:7], s[0:1], 8
    s_load_dwordx2 s[8:9], s[0:1], 16
    s_load_dwordx2 s[10:11], s[0:1], 40
    s_load_dwordx2 s[12:13], s[0:1], 88
    v_and_b32 v1, 63, v0
    v_lshrrev_b32 v4, 6, v0
    v_lshrrev_b32 v2, 4, v1
    v_readfirstlane_b32 s40, v4
    v_and_b32 v3, 15, v1
    s_lshr_b32 s47, s2, 4
    s_and_b32 s48, s2, 15
    s_lshl_b32 s49, s47, 7
    s_lshr_b32 s54, s48, 3
    s_and_b32 s55, s48, 3
    s_cmp_lt_u32 s40, 8
    s_cbranch_scc1 L_k1_c
    s_sub_u32 s40, s40, 8
    s_load_dwordx2 s[72:73], s[0:1], 48
    s_load_dwordx2 s[74:75], s[0:1], 24
    s_load_dwordx2 s[76:77], s[0:1], 64
    s_mul_i32 s52, s55, 352
    s_bfe_u32 s3, s48, 0x10002
    s_mul_i32 s3, s3, 1376
    s_add_u32 s52, s52, s3
    s_lshl_b32 s3, s48, 7
    s_cmp_eq_u32 s54, 1
    s_cselect_b32 s52, s52, s3
    s_mov_b32 s50, 3072
    s_cselect_b32 s50, 2752, s50
    s_cselect_b32 s51, 0, 896
    s_mov_b32 s22, 1572864
    s_cselect_b32 s22, 1409024, s22
    s_mov_b32 s23, 0x00020000
    s_waitcnt lgkmcnt(0)
    s_cselect_b32 s20, s10, s6
    s_cselect_b32 s21, s11, s7
    s_mov_b32 s16, s4
    s_mov_b32 s17, s5
    s_mov_b32 s18, 2097152
    s_mov_b32 s19, 0x00020000
    s_and_b32 s46, s40, 1
    s_lshl_b32 s46, s46, 2
    v_add_u32 v4, s46, v2
    v_and_b32 v5, 7, v1
    v_xor_b32 v4, v4, v5
    v_lshlrev_b32 v4, 4, v4
    s_lshl_b32 s46, s40, 3
    s_add_u32 s46, s46, s49
    v_lshrrev_b32 v5, 3, v1
    v_add_u32 v5, s46, v5
    s_mov_b32 s46, 1024
    v_mad_u32_u24 v8, v5, s46, v4
    v_add_u32 v9, 32768, v8
    v_add_u32 v10, 65536, v8
    v_add_u32 v11, 98304, v8
    s_lshl_b32 s46, s40, 6
    s_add_u32 s46, s46, 0
    v_add_u32 v4, s46, v1
    v_mul_u32_u24 v5, 2731, v4
    v_lshrrev_b32 v5, 16, v5
    v_mul_u32_u24 v6, 24, v5
    v_sub_u32 v4, v4, v6
    v_and_b32 v6, 2, v5
    v_lshrrev_b32 v7, 1, v5
    v_and_b32 v7, 4, v7
    v_or_b32 v6, v6, v7
    v_xor_b32 v4, v4, v6
    v_lshrrev_b32 v6, 3, v4
    v_mul_lo_u32 v6, v6, s51
    v_lshl_add_u32 v4, v4, 4, v6
    v_mul_lo_u32 v5, v5, s50
    v_add3_u32 v12, v4, v5, s52
    s_lshl_b32 s46, s40, 6
    s_add_u32 s46, s46, 256
    v_add_u32 v4, s46, v1
    v_mul_u32_u24 v5, 2731, v4
    v_lshrrev_b32 v5, 16, v5
    v_mul_u32_u24 v6, 24, v5
    v_sub_u32 v4, v4, v6
    v_and_b32 v6, 2, v5
    v_lshrrev_b32 v7, 1, v5
    v_and_b32 v7, 4, v7
    v_or_b32 v6, v6, v7
    v_xor_b32 v4, v4, v6
    v_lshrrev_b32 v6, 3, v4
    v_mul_lo_u32 v6, v6, s51
    v_lshl_add_u32 v4, v4, 4, v6
    v_mul_lo_u32 v5, v5, s50
    v_add3_u32 v13, v4, v5, s52
    s_lshl_b32 s46, s40, 6
    s_add_u32 s46, s46, 512
    v_add_u32 v4, s46, v1
    v_mul_u32_u24 v5, 2731, v4
    v_lshrrev_b32 v5, 16, v5
    v_mul_u32_u24 v6, 24, v5
    v_sub_u32 v4, v4, v6
    v_and_b32 v6, 2, v5
    v_lshrrev_b32 v7, 1, v5
    v_and_b32 v7, 4, v7
    v_or_b32 v6, v6, v7
    v_xor_b32 v4, v4, v6
    v_lshrrev_b32 v6, 3, v4
    v_mul_lo_u32 v6, v6, s51
    v_lshl_add_u32 v4, v4, 4, v6
    v_mul_lo_u32 v5, v5, s50
    v_add3_u32 v14, v4, v5, s52
    s_lshl_b32 s46, s40, 6
    s_add_u32 s46, s46, 768
    v_add_u32 v4, s46, v1
    v_mul_u32_u24 v5, 2731, v4
    v_lshrrev_b32 v5, 16, v5
    v_mul_u32_u24 v6, 24, v5
    v_sub_u32 v4, v4, v6
    v_and_b32 v6, 2, v5
    v_lshrrev_b32 v7, 1, v5
    v_and_b32 v7, 4, v7
    v_or_b32 v6, v6, v7
    v_xor_b32 v4, v4, v6
    v_lshrrev_b32 v6, 3, v4
    v_mul_lo_u32 v6, v6, s51
    v_lshl_add_u32 v4, v4, 4, v6
    v_mul_lo_u32 v5, v5, s50
    v_add3_u32 v15, v4, v5, s52
    s_lshl_b32 s46, s40, 6
    s_add_u32 s46, s46, 1024
    v_add_u32 v4, s46, v1
    v_mul_u32_u24 v5, 2731, v4
    v_lshrrev_b32 v5, 16, v5
    v_mul_u32_u24 v6, 24, v5
    v_sub_u32 v4, v4, v6
    v_and_b32 v6, 2, v5
    v_lshrrev_b32 v7, 1, v5
    v_and_b32 v7, 4, v7
    v_or_b32 v6, v6, v7
    v_xor_b32 v4, v4, v6
    v_lshrrev_b32 v6, 3, v4
    v_mul_lo_u32 v6, v6, s51
    v_lshl_add_u32 v4, v4, 4, v6
    v_mul_lo_u32 v5, v5, s50
    v_add3_u32 v16, v4, v5, s52
    s_lshl_b32 s46, s40, 6
    s_add_u32 s46, s46, 1280
    v_add_u32 v4, s46, v1
    v_mul_u32_u24 v5, 2731, v4
    v_lshrrev_b32 v5, 16, v5
    v_mul_u32_u24 v6, 24, v5
    v_sub_u32 v4, v4, v6
    v_and_b32 v6, 2, v5
    v_lshrrev_b32 v7, 1, v5
    v_and_b32 v7, 4, v7
    v_or_b32 v6, v6, v7
    v_xor_b32 v4, v4, v6
    v_lshrrev_b32 v6, 3, v4
    v_mul_lo_u32 v6, v6, s51
    v_lshl_add_u32 v4, v4, 4, v6
    v_mul_lo_u32 v5, v5, s50
    v_add3_u32 v17, v4, v5, s52
    s_mov_b32 s43, 0
    s_mov_b32 s44, 0
    s_lshl_b32 s50, s50, 6
    s_lshl_b32 s42, s40, 10
    s_add_u32 s41, s42, 122880
    s_mov_b32 s45, 0
L_k1_lpro:
    s_add_u32 m0, s42, 0
    s_nop 0
    buffer_load_dwordx4 v8, s[16:19], s43 offen lds
    s_add_u32 m0, s42, 4096
    s_nop 0
    buffer_load_dwordx4 v9, s[16:19], s43 offen lds
    s_add_u32 m0, s42, 8192
    s_nop 0
    buffer_load_dwordx4 v10, s[16:19], s43 offen lds
    s_add_u32 m0, s42, 12288
    s_nop 0
    buffer_load_dwordx4 v11, s[16:19], s43 offen lds
    s_add_u32 m0, s42, 16384
    s_nop 0
    buffer_load_dwordx4 v12, s[20:23], s44 offen lds
    s_add_u32 m0, s42, 20480
    s_nop 0
    buffer_load_dwordx4 v13, s[20:23], s44 offen lds
    s_add_u32 m0, s42, 24576
    s_nop 0
    buffer_load_dwordx4 v14, s[20:23], s44 offen lds
    s_add_u32 m0, s42, 28672
    s_nop 0
    buffer_load_dwordx4 v15, s[20:23], s44 offen lds
    s_add_u32 m0, s42, 32768
    s_nop 0
    buffer_load_dwordx4 v16, s[20:23], s44 offen lds
    s_add_u32 m0, s42, 36864
    s_nop 0
    buffer_load_dwordx4 v17, s[20:23], s44 offen lds
    s_add_u32 s45, s45, 1
    s_add_u32 s43, s43, 128
    s_add_u32 s44, s44, s50
    s_add_u32 s42, s42, 40960
    s_cmp_eq_u32 s42, s41
    s_cselect_b32 s46, 122880, 0
    s_sub_u32 s42, s42, s46
    s_cmp_lg_u32 s45, 2
    s_cbranch_scc1 L_k1_lpr2
    s_waitcnt vmcnt(10)
    s_barrier
L_k1_lpr2:
    s_cmp_lt_u32 s45, 3
    s_cbranch_scc1 L_k1_lpro
L_k1_lloop:
    s_waitcnt vmcnt(10)
    s_barrier
    s_add_u32 m0, s42, 0
    s_nop 0
    buffer_load_dwordx4 v8, s[16:19], s43 offen lds
    s_add_u32 m0, s42, 4096
    s_nop 0
    buffer_load_dwordx4 v9, s[16:19], s43 offen lds
    s_add_u32 m0, s42, 8192
    s_nop 0
    buffer_load_dwordx4 v10, s[16:19], s43 offen lds
    s_add_u32 m0, s42, 12288
    s_nop 0
    buffer_load_dwordx4 v11, s[16:19], s43 offen lds
    s_add_u32 m0, s42, 16384
    s_nop 0
    buffer_load_dwordx4 v12, s[20:23], s44 offen lds
    s_add_u32 m0, s42, 20480
    s_nop 0
    buffer_load_dwordx4 v13, s[20:23], s44 offen lds
    s_add_u32 m0, s42, 24576
    s_nop 0
    buffer_load_dwordx4 v14, s[20:23], s44 offen lds
    s_add_u32 m0, s42, 28672
    s_nop 0
    buffer_load_dwordx4 v15, s[20:23], s44 offen lds
    s_add_u32 m0, s42, 32768
    s_nop 0
    buffer_load_dwordx4 v16, s[20:23], s44 offen lds
    s_add_u32 m0, s42, 36864
    s_nop 0
    buffer_load_dwordx4 v17, s[20:23], s44 offen lds
    s_add_u32 s45, s45, 1
    s_add_u32 s43, s43, 128
    s_add_u32 s44, s44, s50
    s_add_u32 s42, s42, 40960
    s_cmp_eq_u32 s42, s41
    s_cselect_b32 s46, 122880, 0
    s_sub_u32 s42, s42, s46
    s_cmp_lt_u32 s45, 8
    s_cbranch_scc1 L_k1_lloop
    s_waitcnt vmcnt(10)
    s_barrier
    s_waitcnt vmcnt(0)
    s_barrier
    s_barrier
    s_mov_b32 s24, s72
    s_mov_b32 s25, s73
    s_mov_b32 s26, 8388608
    s_mov_b32 s27, 0x00020000
    s_mov_b32 s28, s74
    s_mov_b32 s29, s75
    s_mov_b32 s30, 524288
    s_mov_b32 s31, 0x00020000
    s_mov_b32 s32, s76
    s_mov_b32 s33, s77
    s_mov_b32 s34, 704512
    s_mov_b32 s35, 0x00020000
    v_lshlrev_b32 v4, 4, v1
    s_and_b32 s3, s2, 7
    s_lshl_b32 s3, s3, 20
    s_lshr_b32 s46, s2, 3
    s_lshl_b32 s46, s46, 15
    s_add_u32 s3, s3, s46
    s_lshl_b32 s46, s40, 13
    s_add_u32 s3, s3, s46
    buffer_load_dwordx4 v[88:91], v4, s[24:27], s3 offen offset:0
    buffer_load_dwordx4 v[92:95], v4, s[24:27], s3 offen offset:1024
    buffer_load_dwordx4 v[96:99], v4, s[24:27], s3 offen offset:2048
    buffer_load_dwordx4 v[100:103], v4, s[24:27], s3 offen offset:3072
    s_add_u32 s3, s3, 4096
    buffer_load_dwordx4 v[104:107], v4, s[24:27], s3 offen offset:0
    buffer_load_dwordx4 v[108:111], v4, s[24:27], s3 offen offset:1024
    buffer_load_dwordx4 v[112:115], v4, s[24:27], s3 offen offset:2048
    buffer_load_dwordx4 v[116:119], v4, s[24:27], s3 offen offset:3072
    s_lshl_b32 s3, s2, 2
    s_add_u32 s3, s3, s40
    s_lshl_b32 s3, s3, 10
    v_add_u32 v4, s3, v4
    buffer_load_dwordx4 v[120:123], v4, s[28:31], 0 offen
    buffer_load_dwordx4 v[124:127], v4, s[32:35], 0 offen
    s_barrier
    s_barrier
    s_endpgm
L_k1_c:
    s_and_b32 s63, s40, 3
    s_lshr_b32 s64, s40, 2
    s_lshl_b32 s3, s64, 6
    s_add_u32 s56, s63, 0
    s_and_b32 s56, s56, 3
    s_lshl_b32 s56, s56, 4
    s_add_u32 s56, s56, s3
    s_add_u32 s57, s63, 1
    s_and_b32 s57, s57, 3
    s_lshl_b32 s57, s57, 4
    s_add_u32 s57, s57, s3
    s_add_u32 s58, s63, 2
    s_and_b32 s58, s58, 3
    s_lshl_b32 s58, s58, 4
    s_add_u32 s58, s58, s3
    s_add_u32 s59, s63, 3
    s_and_b32 s59, s59, 3
    s_lshl_b32 s59, s59, 4
    s_add_u32 s59, s59, s3
    v_lshrrev_b32 v4, 1, v3
    v_xor_b32 v4, v4, v2
    v_lshlrev_b32 v4, 4, v4
    v_lshl_add_u32 v4, v3, 7, v4
    v_xor_b32 v5, 64, v4
    s_lshl_b32 s46, s56, 7
    v_add_u32 v144, s46, v4
    v_add_u32 v148, s46, v5
    s_lshl_b32 s46, s57, 7
    v_add_u32 v145, s46, v4
    v_add_u32 v149, s46, v5
    s_lshl_b32 s46, s58, 7
    v_add_u32 v146, s46, v4
    v_add_u32 v150, s46, v5
    s_lshl_b32 s46, s59, 7
    v_add_u32 v147, s46, v4
    v_add_u32 v151, s46, v5
    v_lshrrev_b32 v4, 2, v3
    v_lshl_add_u32 v4, v2, 3, v4
    v_mul_u32_u24 v4, 384, v4
    v_and_b32 v5, 3, v3
    v_lshl_add_u32 v4, v5, 3, v4
    v_add_u32 v4, 16384, v4
    v_lshrrev_b32 v5, 3, v3
    v_and_b32 v6, 1, v2
    v_lshl_or_b32 v5, v6, 1, v5
    s_add_u32 s46, s63, 0
    v_xor_b32 v6, s46, v5
    v_lshl_add_u32 v160, v6, 5, v4
    s_add_u32 s46, s63, 4
    v_xor_b32 v6, s46, v5
    v_lshl_add_u32 v161, v6, 5, v4
    s_add_u32 s46, s63, 8
    v_xor_b32 v6, s46, v5
    v_lshl_add_u32 v162, v6, 5, v4
    s_waitcnt lgkmcnt(0)
    s_mov_b32 s24, s8
    s_mov_b32 s25, s9
    s_mov_b32 s26, 16384
    s_mov_b32 s27, 0x00020000
    s_mov_b32 s16, s4
    s_mov_b32 s17, s5
    s_mov_b32 s18, 2097152
    s_mov_b32 s19, 0x00020000
    s_mov_b32 s20, s6
    s_mov_b32 s21, s7
    s_mov_b32 s22, 1572864
    s_mov_b32 s23, 0x00020000
    s_mov_b32 s28, s10
    s_mov_b32 s29, s11
    s_mov_b32 s30, 1409024
    s_mov_b32 s31, 0x00020000
    s_lshl_b32 s3, s2, 3
    s_add_u32 s3, s3, s40
    s_lshl_b32 s3, s3, 12
    v_lshlrev_b32 v4, 6, v1
    v_add_u32 v4, s3, v4
    v_subrev_u32 v5, 2097152, v4
    v_subrev_u32 v6, 3670016, v4
    buffer_load_dword v166, v4, s[16:19], 0 offen
    buffer_load_dword v166, v5, s[20:23], 0 offen
    buffer_load_dword v166, v6, s[28:31], 0 offen
    s_lshr_b32 s3, s2, 3
    s_and_b32 s3, s3, 7
    s_xor_b32 s70, s40, 7
    s_lshl_b32 s70, s70, 3
    s_add_u32 s70, s70, s3
    s_cmp_lt_u32 s70, 5
    s_cbranch_scc0 L_k1_nocode
    s_getpc_b64 s[70:71]
L_k1_pc:
    s_sub_u32 s70, s70, L_k1_pc-k1_kernel
    s_subb_u32 s71, s71, 0
    s_lshl_b32 s3, s3, 12
    v_lshlrev_b32 v4, 6, v1
    v_add_u32 v4, s3, v4
    v_min_u32 v4, L_text_end-k1_kernel-4, v4
    v_mov_b32 v57, s71
    v_add_co_u32 v56, vcc, s70, v4
    v_addc_co_u32 v57, vcc, 0, v57, vcc
    global_load_dword v166, v[56:57], off
L_k1_nocode:
    s_and_b32 s3, s48, 7
    s_lshl_b32 s3, s3, 2
    s_add_u32 s3, s3, s63
    s_lshl_b32 s3, s3, 9
    v_lshlrev_b32 v4, 7, v2
    v_lshl_add_u32 v4, v3, 1, v4
    buffer_load_ushort v80, v4, s[24:27], s3 offen offset:0
    buffer_load_ushort v81, v4, s[24:27], s3 offen offset:32
    buffer_load_ushort v82, v4, s[24:27], s3 offen offset:64
    buffer_load_ushort v83, v4, s[24:27], s3 offen offset:96
    v_mov_b32 v68, 0x3f803f80
    v_mov_b32 v69, 0x3f803f80
    v_mov_b32 v70, 0x3f803f80
    v_mov_b32 v71, 0x3f803f80
    v_mov_b32 v56, 0
    v_mov_b32 v57, 0
    v_mov_b32 v58, 0
    v_mov_b32 v59, 0
    v_mov_b32 v60, 0
    v_mov_b32 v61, 0
    v_mov_b32 v62, 0
    v_mov_b32 v63, 0
    v_mov_b32 v64, 0
    v_mov_b32 v65, 0
    v_mov_b32 v66, 0
    v_mov_b32 v67, 0
    v_mov_b32 v72, 0
    v_mov_b32 v73, 0
    v_mov_b32 v74, 0
    v_mov_b32 v75, 0
    v_mov_b32 v76, 0
    v_mov_b32 v77, 0
    v_mov_b32 v78, 0
    v_mov_b32 v79, 0
    v_lshlrev_b32 v4, 2, v2
    v_sub_u32 v4, v3, v4
    v_mov_b32 v5, 0x3f80
    v_mov_b32 v6, 0x3f800000
    v_cmp_eq_u32 vcc, 0, v4
    s_nop 1
    v_cndmask_b32 v84, 0, v5, vcc
    v_cmp_eq_u32 vcc, 1, v4
    s_nop 1
    v_cndmask_b32 v84, v84, v6, vcc
    v_cmp_eq_u32 vcc, 2, v4
    s_nop 1
    v_cndmask_b32 v85, 0, v5, vcc
    v_cmp_eq_u32 vcc, 3, v4
    s_nop 1
    v_cndmask_b32 v85, v85, v6, vcc
    v_cmp_eq_u32 s[70:71], 0, v4
    v_cmp_eq_u32 s[72:73], 1, v4
    v_cmp_eq_u32 s[74:75], 2, v4
    v_cmp_eq_u32 s[76:77], 3, v4
    v_mov_b32 v8, 0
    v_mov_b32 v9, 0
    v_mov_b32 v10, 0
    v_mov_b32 v11, 0
    v_mov_b32 v12, 0
    v_mov_b32 v13, 0
    v_mov_b32 v14, 0
    v_mov_b32 v15, 0
    v_mov_b32 v16, 0
    v_mov_b32 v17, 0
    v_mov_b32 v18, 0
    v_mov_b32 v19, 0
    v_mov_b32 v20, 0
    v_mov_b32 v21, 0
    v_mov_b32 v22, 0
    v_mov_b32 v23, 0
    v_mov_b32 v24, 0
    v_mov_b32 v25, 0
    v_mov_b32 v26, 0
    v_mov_b32 v27, 0
    v_mov_b32 v28, 0
    v_mov_b32 v29, 0
    v_mov_b32 v30, 0
    v_mov_b32 v31, 0
    v_mov_b32 v32, 0
    v_mov_b32 v33, 0
    v_mov_b32 v34, 0
    v_mov_b32 v35, 0
    v_mov_b32 v36, 0
    v_mov_b32 v37, 0
    v_mov_b32 v38, 0
    v_mov_b32 v39, 0
    v_mov_b32 v40, 0
    v_mov_b32 v41, 0
    v_mov_b32 v42, 0
    v_mov_b32 v43, 0
    v_mov_b32 v44, 0
    v_mov_b32 v45, 0
    v_mov_b32 v46, 0
    v_mov_b32 v47, 0
    v_mov_b32 v48, 0
    v_mov_b32 v49, 0
    v_mov_b32 v50, 0
    v_mov_b32 v51, 0
    v_mov_b32 v52, 0
    v_mov_b32 v53, 0
    v_mov_b32 v54, 0
    v_mov_b32 v55, 0
    s_mov_b32 s45, 0
    s_mov_b32 s41, 0
    v_add_u32 v152, s41, v144
    v_add_u32 v153, s41, v145
    v_add_u32 v154, s41, v146
    v_add_u32 v155, s41, v147
    v_add_u32 v156, s41, v148
    v_add_u32 v157, s41, v149
    v_add_u32 v158, s41, v150
    v_add_u32 v159, s41, v151
    v_add_u32 v163, s41, v160
    v_add_u32 v164, s41, v161
    v_add_u32 v165, s41, v162
    s_barrier
    ds_read_b64_tr_b16 v[120:121], v163 offset:0
    ds_read_b64_tr_b16 v[122:123], v163 offset:1536
    ds_read_b64_tr_b16 v[124:125], v164 offset:0
    ds_read_b64_tr_b16 v[126:127], v164 offset:1536
    ds_read_b64_tr_b16 v[128:129], v165 offset:0
    ds_read_b64_tr_b16 v[130:131], v165 offset:1536
    ds_read_b128 v[88:91], v152
    ds_read_b128 v[92:95], v153
    ds_read_b128 v[96:99], v154
    ds_read_b128 v[100:103], v155
L_k1_loop:
    s_waitcnt lgkmcnt(0)
    v_mfma_f32_16x16x32_bf16 v[8:11], v[120:123], v[88:91], v[8:11]
    ds_read_b64_tr_b16 v[132:133], v163 offset:12288
    ds_read_b64_tr_b16 v[134:135], v163 offset:13824
    ds_read_b64_tr_b16 v[136:137], v164 offset:12288
    v_mfma_f32_16x16x32_bf16 v[12:15], v[124:127], v[88:91], v[12:15]
    ds_read_b64_tr_b16 v[138:139], v164 offset:13824
    ds_read_b64_tr_b16 v[140:141], v165 offset:12288
    ds_read_b64_tr_b16 v[142:143], v165 offset:13824
    v_mfma_f32_16x16x32_bf16 v[16:19], v[128:131], v[88:91], v[16:19]
    ds_read_b128 v[104:107], v156
    ds_read_b128 v[108:111], v157
    ds_read_b128 v[112:115], v158
    v_mfma_f32_16x16x32_bf16 v[20:23], v[120:123], v[92:95], v[20:23]
    ds_read_b128 v[116:119], v159
    s_add_u32 s41, s41, 40960
    s_cmp_eq_u32 s41, 122880
    v_mfma_f32_16x16x32_bf16 v[24:27], v[124:127], v[92:95], v[24:27]
    s_cselect_b32 s41, 0, s41
    s_add_u32 s45, s45, 1
    v_add_u32 v152, s41, v144
    v_mfma_f32_16x16x32_bf16 v[28:31], v[128:131], v[92:95], v[28:31]
    v_add_u32 v153, s41, v145
    v_add_u32 v154, s41, v146
    v_add_u32 v155, s41, v147
    v_mfma_f32_16x16x32_bf16 v[32:35], v[120:123], v[96:99], v[32:35]
    v_add_u32 v156, s41, v148
    v_add_u32 v157, s41, v149
    v_add_u32 v158, s41, v150
    v_mfma_f32_16x16x32_bf16 v[36:39], v[124:127], v[96:99], v[36:39]
    v_add_u32 v159, s41, v151
    v_add_u32 v163, s41, v160
    v_add_u32 v164, s41, v161
    v_mfma_f32_16x16x32_bf16 v[40:43], v[128:131], v[96:99], v[40:43]
    v_add_u32 v165, s41, v162
    v_mfma_f32_16x16x32_bf16 v[44:47], v[120:123], v[100:103], v[44:47]
    v_mfma_f32_16x16x32_bf16 v[48:51], v[124:127], v[100:103], v[48:51]
    v_mfma_f32_16x16x32_bf16 v[52:55], v[128:131], v[100:103], v[52:55]
    v_mfma_f32_16x16x32_bf16 v[72:75], v[68:71], v[88:91], v[72:75]
    v_mfma_f32_16x16x32_bf16 v[76:79], v[88:91], v[88:91], v[76:79]
    s_cmp_eq_u32 s64, 0
    s_cbranch_scc0 L_k1_cs0
    v_mfma_f32_16x16x32_bf16 v[56:59], v[120:123], v[68:71], v[56:59]
    v_mfma_f32_16x16x32_bf16 v[60:63], v[124:127], v[68:71], v[60:63]
    v_mfma_f32_16x16x32_bf16 v[64:67], v[128:131], v[68:71], v[64:67]
    L_k1_cs0:
    s_waitcnt lgkmcnt(0)
    s_barrier
    v_mfma_f32_16x16x32_bf16 v[8:11], v[132:135], v[104:107], v[8:11]
    ds_read_b64_tr_b16 v[120:121], v163 offset:0
    v_mfma_f32_16x16x32_bf16 v[12:15], v[136:139], v[104:107], v[12:15]
    ds_read_b64_tr_b16 v[122:123], v163 offset:1536
    v_mfma_f32_16x16x32_bf16 v[16:19], v[140:143], v[104:107], v[16:19]
    ds_read_b64_tr_b16 v[124:125], v164 offset:0
    v_mfma_f32_16x16x32_bf16 v[20:23], v[132:135], v[108:111], v[20:23]
    ds_read_b64_tr_b16 v[126:127], v164 offset:1536
    v_mfma_f32_16x16x32_bf16 v[24:27], v[136:139], v[108:111], v[24:27]
    ds_read_b64_tr_b16 v[128:129], v165 offset:0
    v_mfma_f32_16x16x32_bf16 v[28:31], v[140:143], v[108:111], v[28:31]
    ds_read_b64_tr_b16 v[130:131], v165 offset:1536
    v_mfma_f32_16x16x32_bf16 v[32:35], v[132:135], v[112:115], v[32:35]
    ds_read_b128 v[88:91], v152
    v_mfma_f32_16x16x32_bf16 v[36:39], v[136:139], v[112:115], v[36:39]
    ds_read_b128 v[92:95], v153
    v_mfma_f32_16x16x32_bf16 v[40:43], v[140:143], v[112:115], v[40:43]
    ds_read_b128 v[96:99], v154
    v_mfma_f32_16x16x32_bf16 v[44:47], v[132:135], v[116:119], v[44:47]
    ds_read_b128 v[100:103], v155
    v_mfma_f32_16x16x32_bf16 v[48:51], v[136:139], v[116:119], v[48:51]
    v_mfma_f32_16x16x32_bf16 v[52:55], v[140:143], v[116:119], v[52:55]
    v_mfma_f32_16x16x32_bf16 v[72:75], v[68:71], v[104:107], v[72:75]
    v_mfma_f32_16x16x32_bf16 v[76:79], v[104:107], v[104:107], v[76:79]
    s_cmp_eq_u32 s64, 1
    s_cbranch_scc0 L_k1_cs1
    v_mfma_f32_16x16x32_bf16 v[56:59], v[132:135], v[68:71], v[56:59]
    v_mfma_f32_16x16x32_bf16 v[60:63], v[136:139], v[68:71], v[60:63]
    v_mfma_f32_16x16x32_bf16 v[64:67], v[140:143], v[68:71], v[64:67]
    L_k1_cs1:
L_k1_hback:
    s_cmp_lt_u32 s45, 8
    s_cbranch_scc1 L_k1_loop
    s_waitcnt lgkmcnt(0)
    s_nop 7
    s_mul_i32 s46, s40, 192
    s_add_u32 s46, s46, 33792
    v_lshlrev_b32 v94, 4, v2
    v_add_u32 v94, s46, v94
    ds_write_b128 v94, v[56:59] offset:0
    ds_write_b128 v94, v[60:63] offset:64
    ds_write_b128 v94, v[64:67] offset:128
    v_cndmask_b32 v76, 0, v76, s[70:71]
    v_cndmask_b32 v76, v76, v77, s[72:73]
    v_cndmask_b32 v76, v76, v78, s[74:75]
    v_cndmask_b32 v76, v76, v79, s[76:77]
    v_mov_b32 v88, v76
    s_nop 1
    v_permlane32_swap_b32 v76, v88
    s_nop 0
    v_add_f32 v76, v76, v88
    v_mov_b32 v88, v76
    s_nop 1
    v_permlane16_swap_b32 v76, v88
    s_nop 0
    v_add_f32 v76, v76, v88
    s_mov_b32 s3, 989855744
    v_lshlrev_b32 v92, 3, v3
    s_lshl_b32 s46, s56, 3
    s_add_u32 s46, s46, 32768
    v_add_u32 v93, s46, v92
    v_mul_f32 v96, s3, v72
    v_mul_f32 v97, s3, v76
    v_fma_f32 v97, -v96, v96, v97
    v_max_f32 v97, 0, v97
    v_add_f32 v97, 925353388, v97
    v_rsq_f32 v97, v97
    s_xor_b32 s46, s40, 4
    s_mul_i32 s46, s46, 192
    s_add_u32 s46, s46, 33792
    ds_write_b64 v93, v[96:97]
    v_lshlrev_b32 v94, 4, v2
    v_add_u32 v94, s46, v94
    s_lshl_b32 s46, s57, 3
    s_add_u32 s46, s46, 32768
    v_add_u32 v89, s46, v92
    s_lshl_b32 s46, s58, 3
    s_add_u32 s46, s46, 32768
    v_add_u32 v90, s46, v92
    s_lshl_b32 s46, s59, 3
    s_add_u32 s46, s46, 32768
    v_add_u32 v91, s46, v92
    s_waitcnt lgkmcnt(0)
    s_barrier
    ds_read_b128 v[108:111], v94 offset:0
    ds_read_b128 v[112:115], v94 offset:64
    ds_read_b128 v[116:119], v94 offset:128
    ds_read_b64 v[98:99], v89
    ds_read_b64 v[100:101], v90
    ds_read_b64 v[102:103], v91
    s_add_u32 s46, s56, s49
    v_add_u32 v104, s46, v3
    s_add_u32 s46, s57, s49
    v_add_u32 v105, s46, v3
    s_add_u32 s46, s58, s49
    v_add_u32 v106, s46, v3
    s_add_u32 s46, s59, s49
    v_add_u32 v107, s46, v3
    s_waitcnt lgkmcnt(3)
    v_add_f32 v56, v56, v108
    v_add_f32 v57, v57, v109
    v_add_f32 v58, v58, v110
    v_add_f32 v59, v59, v111
    v_add_f32 v60, v60, v112
    v_add_f32 v61, v61, v113
    v_add_f32 v62, v62, v114
    v_add_f32 v63, v63, v115
    v_add_f32 v64, v64, v116
    v_add_f32 v65, v65, v117
    v_add_f32 v66, v66, v118
    v_add_f32 v67, v67, v119
    s_waitcnt lgkmcnt(0)
    v_pk_fma_f32 v[8:9], v[56:57], v[96:97], v[8:9] op_sel:[0,0,0] op_sel_hi:[1,0,1] neg_lo:[1,0,0] neg_hi:[1,0,0]
    v_pk_fma_f32 v[10:11], v[58:59], v[96:97], v[10:11] op_sel:[0,0,0] op_sel_hi:[1,0,1] neg_lo:[1,0,0] neg_hi:[1,0,0]
    v_pk_mul_f32 v[8:9], v[8:9], v[96:97] op_sel:[0,1] op_sel_hi:[1,1]
    v_pk_mul_f32 v[10:11], v[10:11], v[96:97] op_sel:[0,1] op_sel_hi:[1,1]
    v_pk_fma_f32 v[12:13], v[60:61], v[96:97], v[12:13] op_sel:[0,0,0] op_sel_hi:[1,0,1] neg_lo:[1,0,0] neg_hi:[1,0,0]
    v_pk_fma_f32 v[14:15], v[62:63], v[96:97], v[14:15] op_sel:[0,0,0] op_sel_hi:[1,0,1] neg_lo:[1,0,0] neg_hi:[1,0,0]
    v_pk_mul_f32 v[12:13], v[12:13], v[96:97] op_sel:[0,1] op_sel_hi:[1,1]
    v_pk_mul_f32 v[14:15], v[14:15], v[96:97] op_sel:[0,1] op_sel_hi:[1,1]
    v_pk_fma_f32 v[16:17], v[64:65], v[96:97], v[16:17] op_sel:[0,0,0] op_sel_hi:[1,0,1] neg_lo:[1,0,0] neg_hi:[1,0,0]
    v_pk_fma_f32 v[18:19], v[66:67], v[96:97], v[18:19] op_sel:[0,0,0] op_sel_hi:[1,0,1] neg_lo:[1,0,0] neg_hi:[1,0,0]
    v_pk_mul_f32 v[16:17], v[16:17], v[96:97] op_sel:[0,1] op_sel_hi:[1,1]
    v_pk_mul_f32 v[18:19], v[18:19], v[96:97] op_sel:[0,1] op_sel_hi:[1,1]
    v_pk_fma_f32 v[20:21], v[56:57], v[98:99], v[20:21] op_sel:[0,0,0] op_sel_hi:[1,0,1] neg_lo:[1,0,0] neg_hi:[1,0,0]
    v_pk_fma_f32 v[22:23], v[58:59], v[98:99], v[22:23] op_sel:[0,0,0] op_sel_hi:[1,0,1] neg_lo:[1,0,0] neg_hi:[1,0,0]
    v_pk_mul_f32 v[20:21], v[20:21], v[98:99] op_sel:[0,1] op_sel_hi:[1,1]
    v_pk_mul_f32 v[22:23], v[22:23], v[98:99] op_sel:[0,1] op_sel_hi:[1,1]
    v_pk_fma_f32 v[24:25], v[60:61], v[98:99], v[24:25] op_sel:[0,0,0] op_sel_hi:[1,0,1] neg_lo:[1,0,0] neg_hi:[1,0,0]
    v_pk_fma_f32 v[26:27], v[62:63], v[98:99], v[26:27] op_sel:[0,0,0] op_sel_hi:[1,0,1] neg_lo:[1,0,0] neg_hi:[1,0,0]
    v_pk_mul_f32 v[24:25], v[24:25], v[98:99] op_sel:[0,1] op_sel_hi:[1,1]
    v_pk_mul_f32 v[26:27], v[26:27], v[98:99] op_sel:[0,1] op_sel_hi:[1,1]
    v_pk_fma_f32 v[28:29], v[64:65], v[98:99], v[28:29] op_sel:[0,0,0] op_sel_hi:[1,0,1] neg_lo:[1,0,0] neg_hi:[1,0,0]
    v_pk_fma_f32 v[30:31], v[66:67], v[98:99], v[30:31] op_sel:[0,0,0] op_sel_hi:[1,0,1] neg_lo:[1,0,0] neg_hi:[1,0,0]
    v_pk_mul_f32 v[28:29], v[28:29], v[98:99] op_sel:[0,1] op_sel_hi:[1,1]
    v_pk_mul_f32 v[30:31], v[30:31], v[98:99] op_sel:[0,1] op_sel_hi:[1,1]
    v_pk_fma_f32 v[32:33], v[56:57], v[100:101], v[32:33] op_sel:[0,0,0] op_sel_hi:[1,0,1] neg_lo:[1,0,0] neg_hi:[1,0,0]
    v_pk_fma_f32 v[34:35], v[58:59], v[100:101], v[34:35] op_sel:[0,0,0] op_sel_hi:[1,0,1] neg_lo:[1,0,0] neg_hi:[1,0,0]
    v_pk_mul_f32 v[32:33], v[32:33], v[100:101] op_sel:[0,1] op_sel_hi:[1,1]
    v_pk_mul_f32 v[34:35], v[34:35], v[100:101] op_sel:[0,1] op_sel_hi:[1,1]
    v_pk_fma_f32 v[36:37], v[60:61], v[100:101], v[36:37] op_sel:[0,0,0] op_sel_hi:[1,0,1] neg_lo:[1,0,0] neg_hi:[1,0,0]
    v_pk_fma_f32 v[38:39], v[62:63], v[100:101], v[38:39] op_sel:[0,0,0] op_sel_hi:[1,0,1] neg_lo:[1,0,0] neg_hi:[1,0,0]
    v_pk_mul_f32 v[36:37], v[36:37], v[100:101] op_sel:[0,1] op_sel_hi:[1,1]
    v_pk_mul_f32 v[38:39], v[38:39], v[100:101] op_sel:[0,1] op_sel_hi:[1,1]
    v_pk_fma_f32 v[40:41], v[64:65], v[100:101], v[40:41] op_sel:[0,0,0] op_sel_hi:[1,0,1] neg_lo:[1,0,0] neg_hi:[1,0,0]
    v_pk_fma_f32 v[42:43], v[66:67], v[100:101], v[42:43] op_sel:[0,0,0] op_sel_hi:[1,0,1] neg_lo:[1,0,0] neg_hi:[1,0,0]
    v_pk_mul_f32 v[40:41], v[40:41], v[100:101] op_sel:[0,1] op_sel_hi:[1,1]
    v_pk_mul_f32 v[42:43], v[42:43], v[100:101] op_sel:[0,1] op_sel_hi:[1,1]
    v_pk_fma_f32 v[44:45], v[56:57], v[102:103], v[44:45] op_sel:[0,0,0] op_sel_hi:[1,0,1] neg_lo:[1,0,0] neg_hi:[1,0,0]
    v_pk_fma_f32 v[46:47], v[58:59], v[102:103], v[46:47] op_sel:[0,0,0] op_sel_hi:[1,0,1] neg_lo:[1,0,0] neg_hi:[1,0,0]
    v_pk_mul_f32 v[44:45], v[44:45], v[102:103] op_sel:[0,1] op_sel_hi:[1,1]
    v_pk_mul_f32 v[46:47], v[46:47], v[102:103] op_sel:[0,1] op_sel_hi:[1,1]
    v_pk_fma_f32 v[48:49], v[60:61], v[102:103], v[48:49] op_sel:[0,0,0] op_sel_hi:[1,0,1] neg_lo:[1,0,0] neg_hi:[1,0,0]
    v_pk_fma_f32 v[50:51], v[62:63], v[102:103], v[50:51] op_sel:[0,0,0] op_sel_hi:[1,0,1] neg_lo:[1,0,0] neg_hi:[1,0,0]
    v_pk_mul_f32 v[48:49], v[48:49], v[102:103] op_sel:[0,1] op_sel_hi:[1,1]
    v_pk_mul_f32 v[50:51], v[50:51], v[102:103] op_sel:[0,1] op_sel_hi:[1,1]
    v_pk_fma_f32 v[52:53], v[64:65], v[102:103], v[52:53] op_sel:[0,0,0] op_sel_hi:[1,0,1] neg_lo:[1,0,0] neg_hi:[1,0,0]
    v_pk_fma_f32 v[54:55], v[66:67], v[102:103], v[54:55] op_sel:[0,0,0] op_sel_hi:[1,0,1] neg_lo:[1,0,0] neg_hi:[1,0,0]
    v_pk_mul_f32 v[52:53], v[52:53], v[102:103] op_sel:[0,1] op_sel_hi:[1,1]
    v_pk_mul_f32 v[54:55], v[54:55], v[102:103] op_sel:[0,1] op_sel_hi:[1,1]
    s_cmp_eq_u32 s54, 1
    s_cbranch_scc1 L_k1_z
    s_mov_b32 s28, s12
    s_mov_b32 s29, s13
    s_mov_b32 s30, 4194304
    s_mov_b32 s31, 0x00020000
    s_add_u32 s32, s12, 17825792
    s_addc_u32 s33, s13, 0
    s_mov_b32 s34, 2097152
    s_mov_b32 s35, 0x00020000
    s_mov_b32 s53, 1069066811
    s_mov_b32 s68, 1069066811
    s_mov_b32 s69, 1069066811
    v_mov_b32 v108, 0
    v_mov_b32 v109, 0
    v_mov_b32 v110, 0
    v_mov_b32 v111, 0
    v_mov_b32 v112, 0
    v_mov_b32 v113, 0
    v_mov_b32 v114, 0
    v_mov_b32 v115, 0
    v_mov_b32 v116, 0
    v_mov_b32 v117, 0
    v_mov_b32 v118, 0
    v_mov_b32 v119, 0
    v_mov_b32 v120, 0
    v_mov_b32 v121, 0
    v_mov_b32 v122, 0
    v_mov_b32 v123, 0
    s_waitcnt vmcnt(0)
    v_lshl_or_b32 v80, v81, 16, v80
    v_lshl_or_b32 v81, v83, 16, v82
    v_cvt_pk_bf16_f32 v124, v8, v9
    v_cvt_pk_bf16_f32 v125, v10, v11
    v_cvt_pk_bf16_f32 v126, v12, v13
    v_cvt_pk_bf16_f32 v127, v14, v15
    v_cvt_pk_bf16_f32 v128, v16, v17
    v_cvt_pk_bf16_f32 v129, v18, v19
    s_nop 1
    v_mfma_f32_16x16x16_bf16 v[8:11], v[80:81], v[124:125], 0
    v_mfma_f32_16x16x16_bf16 v[12:15], v[80:81], v[126:127], 0
    v_mfma_f32_16x16x16_bf16 v[16:19], v[128:129], v[84:85], 0
    v_cvt_pk_bf16_f32 v130, v20, v21
    v_cvt_pk_bf16_f32 v131, v22, v23
    v_cvt_pk_bf16_f32 v132, v24, v25
    v_cvt_pk_bf16_f32 v133, v26, v27
    v_cvt_pk_bf16_f32 v134, v28, v29
    v_cvt_pk_bf16_f32 v135, v30, v31
    s_nop 1
    v_mfma_f32_16x16x16_bf16 v[20:23], v[80:81], v[130:131], 0
    v_mfma_f32_16x16x16_bf16 v[24:27], v[80:81], v[132:133], 0
    v_mfma_f32_16x16x16_bf16 v[28:31], v[134:135], v[84:85], 0
    v_cvt_pk_bf16_f32 v124, v32, v33
    v_cvt_pk_bf16_f32 v125, v34, v35
    v_cvt_pk_bf16_f32 v126, v36, v37
    v_cvt_pk_bf16_f32 v127, v38, v39
    v_cvt_pk_bf16_f32 v128, v40, v41
    v_cvt_pk_bf16_f32 v129, v42, v43
    s_nop 1
    v_mfma_f32_16x16x16_bf16 v[32:35], v[80:81], v[124:125], 0
    v_mfma_f32_16x16x16_bf16 v[36:39], v[80:81], v[126:127], 0
    v_mfma_f32_16x16x16_bf16 v[40:43], v[128:129], v[84:85], 0
    v_cvt_pk_bf16_f32 v130, v44, v45
    v_cvt_pk_bf16_f32 v131, v46, v47
    v_cvt_pk_bf16_f32 v132, v48, v49
    v_cvt_pk_bf16_f32 v133, v50, v51
    v_cvt_pk_bf16_f32 v134, v52, v53
    v_cvt_pk_bf16_f32 v135, v54, v55
    s_nop 1
    v_mfma_f32_16x16x16_bf16 v[44:47], v[80:81], v[130:131], 0
    v_mfma_f32_16x16x16_bf16 v[48:51], v[80:81], v[132:133], 0
    v_mfma_f32_16x16x16_bf16 v[52:55], v[134:135], v[84:85], 0
    s_and_b32 s3, s48, 7
    s_lshl_b32 s3, s3, 2
    s_add_u32 s3, s3, s63
    s_lshl_b32 s46, s3, 6
    v_lshlrev_b32 v94, 4, v2
    v_add_u32 v94, s46, v94
    s_nop 4
    v_max3_f32 v136, v8, v9, v10
    v_max3_f32 v138, -v8, -v9, -v10
    v_max_f32 v136, v136, v11
    v_max_f32_e64 v138, v138, -v11
    v_max3_f32 v137, v12, v13, v14
    v_max3_f32 v139, -v12, -v13, -v14
    v_max_f32 v137, v137, v15
    v_max_f32_e64 v139, v139, -v15
    s_nop 1
    v_permlane32_swap_b32 v136, v137
    v_permlane32_swap_b32 v138, v139
    s_nop 0
    v_max_f32 v136, v136, v137
    v_max_f32 v138, v138, v139
    s_nop 1
    v_permlane16_swap_b32 v136, v138
    s_nop 0
    v_max_f32 v136, v136, v138
    v_mul_f32 v136, s53, v136
    v_mov_b32 v138, v136
    s_nop 1
    v_permlane16_swap_b32 v136, v138
    s_nop 0
    v_mov_b32 v137, v136
    v_mov_b32 v139, v138
    s_nop 1
    v_permlane32_swap_b32 v136, v137
    v_permlane32_swap_b32 v138, v139
    s_nop 0
    v_pk_fma_f32 v[140:141], v[8:9], s[68:69], v[136:137] op_sel:[0,0,0] op_sel_hi:[1,1,0] neg_lo:[0,0,1] neg_hi:[0,0,1]
    v_pk_fma_f32 v[144:145], v[8:9], s[68:69], v[138:139] op_sel:[0,0,0] op_sel_hi:[1,1,0] neg_lo:[1,0,1] neg_hi:[1,0,1]
    v_pk_fma_f32 v[142:143], v[10:11], s[68:69], v[136:137] op_sel:[0,0,0] op_sel_hi:[1,1,0] neg_lo:[0,0,1] neg_hi:[0,0,1]
    v_pk_fma_f32 v[146:147], v[10:11], s[68:69], v[138:139] op_sel:[0,0,0] op_sel_hi:[1,1,0] neg_lo:[1,0,1] neg_hi:[1,0,1]
    v_pk_fma_f32 v[148:149], v[12:13], s[68:69], v[136:137] op_sel:[0,0,1] op_sel_hi:[1,1,1] neg_lo:[0,0,1] neg_hi:[0,0,1]
    v_pk_fma_f32 v[152:153], v[12:13], s[68:69], v[138:139] op_sel:[0,0,1] op_sel_hi:[1,1,1] neg_lo:[1,0,1] neg_hi:[1,0,1]
    v_pk_fma_f32 v[150:151], v[14:15], s[68:69], v[136:137] op_sel:[0,0,1] op_sel_hi:[1,1,1] neg_lo:[0,0,1] neg_hi:[0,0,1]
    v_pk_fma_f32 v[154:155], v[14:15], s[68:69], v[138:139] op_sel:[0,0,1] op_sel_hi:[1,1,1] neg_lo:[1,0,1] neg_hi:[1,0,1]
    v_exp_f32 v140, v140
    v_exp_f32 v141, v141
    v_exp_f32 v142, v142
    v_exp_f32 v143, v143
    v_exp_f32 v144, v144
    v_exp_f32 v145, v145
    v_exp_f32 v146, v146
    v_exp_f32 v147, v147
    v_exp_f32 v148, v148
    v_exp_f32 v149, v149
    v_exp_f32 v150, v150
    v_exp_f32 v151, v151
    v_exp_f32 v152, v152
    v_exp_f32 v153, v153
    v_exp_f32 v154, v154
    v_exp_f32 v155, v155
    v_cvt_pk_bf16_f32 v132, v16, v17
    v_cvt_pk_bf16_f32 v133, v18, v19
    v_pk_add_f32 v[88:89], v[140:141], v[142:143]
    v_add_f32 v136, v88, v89
    v_pk_add_f32 v[90:91], v[144:145], v[146:147]
    v_add_f32 v138, v90, v91
    v_pk_add_f32 v[88:89], v[148:149], v[150:151]
    v_add_f32 v137, v88, v89
    v_pk_add_f32 v[90:91], v[152:153], v[154:155]
    v_add_f32 v139, v90, v91
    s_nop 1
    v_permlane32_swap_b32 v136, v137
    v_permlane32_swap_b32 v138, v139
    s_nop 0
    v_add_f32 v136, v136, v137
    v_add_f32 v138, v138, v139
    s_nop 1
    v_permlane16_swap_b32 v136, v138
    s_nop 0
    v_add_f32 v136, v136, v138
    v_rcp_f32 v136, v136
    v_lshl_add_u32 v95, v104, 11, v94
    v_mov_b32 v138, v136
    s_nop 1
    v_permlane16_swap_b32 v136, v138
    s_nop 0
    v_mov_b32 v137, v136
    v_mov_b32 v139, v138
    s_nop 1
    v_permlane32_swap_b32 v136, v137
    v_permlane32_swap_b32 v138, v139
    s_nop 0
    v_pk_mul_f32 v[140:141], v[140:141], v[136:137] op_sel:[0,0] op_sel_hi:[1,0]
    v_pk_mul_f32 v[142:143], v[142:143], v[136:137] op_sel:[0,0] op_sel_hi:[1,0]
    v_pk_mul_f32 v[144:145], v[144:145], v[138:139] op_sel:[0,0] op_sel_hi:[1,0]
    v_pk_mul_f32 v[146:147], v[146:147], v[138:139] op_sel:[0,0] op_sel_hi:[1,0]
    v_pk_mul_f32 v[148:149], v[148:149], v[136:137] op_sel:[0,1] op_sel_hi:[1,1]
    v_pk_mul_f32 v[150:151], v[150:151], v[136:137] op_sel:[0,1] op_sel_hi:[1,1]
    v_pk_mul_f32 v[152:153], v[152:153], v[138:139] op_sel:[0,1] op_sel_hi:[1,1]
    v_pk_mul_f32 v[154:155], v[154:155], v[138:139] op_sel:[0,1] op_sel_hi:[1,1]
    v_cvt_pk_bf16_f32 v8, v140, v141
    v_cvt_pk_bf16_f32 v9, v142, v143
    v_cvt_pk_bf16_f32 v124, v148, v149
    v_cvt_pk_bf16_f32 v125, v150, v151
    v_cvt_pk_bf16_f32 v10, v144, v145
    v_cvt_pk_bf16_f32 v11, v146, v147
    v_cvt_pk_bf16_f32 v126, v152, v153
    v_cvt_pk_bf16_f32 v127, v154, v155
    buffer_store_dwordx4 v[8:11], v95, s[28:31], 0 offen
    s_nop 0
    v_mfma_f32_16x16x16_bf16 v[156:159], v[124:125], v[84:85], 0
    v_mfma_f32_16x16x16_bf16 v[160:163], v[126:127], v[84:85], 0
    s_nop 7
    v_cvt_pk_bf16_f32 v128, v156, v157
    v_cvt_pk_bf16_f32 v129, v158, v159
    v_cvt_pk_bf16_f32 v130, v160, v161
    v_cvt_pk_bf16_f32 v131, v162, v163
    s_nop 1
    v_mfma_f32_16x16x16_bf16 v[108:111], v[128:129], v[132:133], v[108:111]
    v_mfma_f32_16x16x16_bf16 v[116:119], v[128:129], v[68:69], v[116:119]
    v_mfma_f32_16x16x16_bf16 v[112:115], v[130:131], v[132:133], v[112:115]
    v_mfma_f32_16x16x16_bf16 v[120:123], v[130:131], v[68:69], v[120:123]
    v_max3_f32 v136, v20, v21, v22
    v_max3_f32 v138, -v20, -v21, -v22
    v_max_f32 v136, v136, v23
    v_max_f32_e64 v138, v138, -v23
    v_max3_f32 v137, v24, v25, v26
    v_max3_f32 v139, -v24, -v25, -v26
    v_max_f32 v137, v137, v27
    v_max_f32_e64 v139, v139, -v27
    s_nop 1
    v_permlane32_swap_b32 v136, v137
    v_permlane32_swap_b32 v138, v139
    s_nop 0
    v_max_f32 v136, v136, v137
    v_max_f32 v138, v138, v139
    s_nop 1
    v_permlane16_swap_b32 v136, v138
    s_nop 0
    v_max_f32 v136, v136, v138
    v_mul_f32 v136, s53, v136
    v_mov_b32 v138, v136
    s_nop 1
    v_permlane16_swap_b32 v136, v138
    s_nop 0
    v_mov_b32 v137, v136
    v_mov_b32 v139, v138
    s_nop 1
    v_permlane32_swap_b32 v136, v137
    v_permlane32_swap_b32 v138, v139
    s_nop 0
    v_pk_fma_f32 v[140:141], v[20:21], s[68:69], v[136:137] op_sel:[0,0,0] op_sel_hi:[1,1,0] neg_lo:[0,0,1] neg_hi:[0,0,1]
    v_pk_fma_f32 v[144:145], v[20:21], s[68:69], v[138:139] op_sel:[0,0,0] op_sel_hi:[1,1,0] neg_lo:[1,0,1] neg_hi:[1,0,1]
    v_pk_fma_f32 v[142:143], v[22:23], s[68:69], v[136:137] op_sel:[0,0,0] op_sel_hi:[1,1,0] neg_lo:[0,0,1] neg_hi:[0,0,1]
    v_pk_fma_f32 v[146:147], v[22:23], s[68:69], v[138:139] op_sel:[0,0,0] op_sel_hi:[1,1,0] neg_lo:[1,0,1] neg_hi:[1,0,1]
    v_pk_fma_f32 v[148:149], v[24:25], s[68:69], v[136:137] op_sel:[0,0,1] op_sel_hi:[1,1,1] neg_lo:[0,0,1] neg_hi:[0,0,1]
    v_pk_fma_f32 v[152:153], v[24:25], s[68:69], v[138:139] op_sel:[0,0,1] op_sel_hi:[1,1,1] neg_lo:[1,0,1] neg_hi:[1,0,1]
    v_pk_fma_f32 v[150:151], v[26:27], s[68:69], v[136:137] op_sel:[0,0,1] op_sel_hi:[1,1,1] neg_lo:[0,0,1] neg_hi:[0,0,1]
    v_pk_fma_f32 v[154:155], v[26:27], s[68:69], v[138:139] op_sel:[0,0,1] op_sel_hi:[1,1,1] neg_lo:[1,0,1] neg_hi:[1,0,1]
    v_exp_f32 v140, v140
    v_exp_f32 v141, v141
    v_exp_f32 v142, v142
    v_exp_f32 v143, v143
    v_exp_f32 v144, v144
    v_exp_f32 v145, v145
    v_exp_f32 v146, v146
    v_exp_f32 v147, v147
    v_exp_f32 v148, v148
    v_exp_f32 v149, v149
    v_exp_f32 v150, v150
    v_exp_f32 v151, v151
    v_exp_f32 v152, v152
    v_exp_f32 v153, v153
    v_exp_f32 v154, v154
    v_exp_f32 v155, v155
    v_cvt_pk_bf16_f32 v132, v28, v29
    v_cvt_pk_bf16_f32 v133, v30, v31
    v_pk_add_f32 v[88:89], v[140:141], v[142:143]
    v_add_f32 v136, v88, v89
    v_pk_add_f32 v[90:91], v[144:145], v[146:147]
    v_add_f32 v138, v90, v91
    v_pk_add_f32 v[88:89], v[148:149], v[150:151]
    v_add_f32 v137, v88, v89
    v_pk_add_f32 v[90:91], v[152:153], v[154:155]
    v_add_f32 v139, v90, v91
    s_nop 1
    v_permlane32_swap_b32 v136, v137
    v_permlane32_swap_b32 v138, v139
    s_nop 0
    v_add_f32 v136, v136, v137
    v_add_f32 v138, v138, v139
    s_nop 1
    v_permlane16_swap_b32 v136, v138
    s_nop 0
    v_add_f32 v136, v136, v138
    v_rcp_f32 v136, v136
    v_lshl_add_u32 v95, v105, 11, v94
    v_mov_b32 v138, v136
    s_nop 1
    v_permlane16_swap_b32 v136, v138
    s_nop 0
    v_mov_b32 v137, v136
    v_mov_b32 v139, v138
    s_nop 1
    v_permlane32_swap_b32 v136, v137
    v_permlane32_swap_b32 v138, v139
    s_nop 0
    v_pk_mul_f32 v[140:141], v[140:141], v[136:137] op_sel:[0,0] op_sel_hi:[1,0]
    v_pk_mul_f32 v[142:143], v[142:143], v[136:137] op_sel:[0,0] op_sel_hi:[1,0]
    v_pk_mul_f32 v[144:145], v[144:145], v[138:139] op_sel:[0,0] op_sel_hi:[1,0]
    v_pk_mul_f32 v[146:147], v[146:147], v[138:139] op_sel:[0,0] op_sel_hi:[1,0]
    v_pk_mul_f32 v[148:149], v[148:149], v[136:137] op_sel:[0,1] op_sel_hi:[1,1]
    v_pk_mul_f32 v[150:151], v[150:151], v[136:137] op_sel:[0,1] op_sel_hi:[1,1]
    v_pk_mul_f32 v[152:153], v[152:153], v[138:139] op_sel:[0,1] op_sel_hi:[1,1]
    v_pk_mul_f32 v[154:155], v[154:155], v[138:139] op_sel:[0,1] op_sel_hi:[1,1]
    v_cvt_pk_bf16_f32 v20, v140, v141
    v_cvt_pk_bf16_f32 v21, v142, v143
    v_cvt_pk_bf16_f32 v124, v148, v149
    v_cvt_pk_bf16_f32 v125, v150, v151
    v_cvt_pk_bf16_f32 v22, v144, v145
    v_cvt_pk_bf16_f32 v23, v146, v147
    v_cvt_pk_bf16_f32 v126, v152, v153
    v_cvt_pk_bf16_f32 v127, v154, v155
    buffer_store_dwordx4 v[20:23], v95, s[28:31], 0 offen
    s_nop 0
    v_mfma_f32_16x16x16_bf16 v[156:159], v[124:125], v[84:85], 0
    v_mfma_f32_16x16x16_bf16 v[160:163], v[126:127], v[84:85], 0
    s_nop 7
    v_cvt_pk_bf16_f32 v128, v156, v157
    v_cvt_pk_bf16_f32 v129, v158, v159
    v_cvt_pk_bf16_f32 v130, v160, v161
    v_cvt_pk_bf16_f32 v131, v162, v163
    s_nop 1
    v_mfma_f32_16x16x16_bf16 v[108:111], v[128:129], v[132:133], v[108:111]
    v_mfma_f32_16x16x16_bf16 v[116:119], v[128:129], v[68:69], v[116:119]
    v_mfma_f32_16x16x16_bf16 v[112:115], v[130:131], v[132:133], v[112:115]
    v_mfma_f32_16x16x16_bf16 v[120:123], v[130:131], v[68:69], v[120:123]
    v_max3_f32 v136, v32, v33, v34
    v_max3_f32 v138, -v32, -v33, -v34
    v_max_f32 v136, v136, v35
    v_max_f32_e64 v138, v138, -v35
    v_max3_f32 v137, v36, v37, v38
    v_max3_f32 v139, -v36, -v37, -v38
    v_max_f32 v137, v137, v39
    v_max_f32_e64 v139, v139, -v39
    s_nop 1
    v_permlane32_swap_b32 v136, v137
    v_permlane32_swap_b32 v138, v139
    s_nop 0
    v_max_f32 v136, v136, v137
    v_max_f32 v138, v138, v139
    s_nop 1
    v_permlane16_swap_b32 v136, v138
    s_nop 0
    v_max_f32 v136, v136, v138
    v_mul_f32 v136, s53, v136
    v_mov_b32 v138, v136
    s_nop 1
    v_permlane16_swap_b32 v136, v138
    s_nop 0
    v_mov_b32 v137, v136
    v_mov_b32 v139, v138
    s_nop 1
    v_permlane32_swap_b32 v136, v137
    v_permlane32_swap_b32 v138, v139
    s_nop 0
    v_pk_fma_f32 v[140:141], v[32:33], s[68:69], v[136:137] op_sel:[0,0,0] op_sel_hi:[1,1,0] neg_lo:[0,0,1] neg_hi:[0,0,1]
    v_pk_fma_f32 v[144:145], v[32:33], s[68:69], v[138:139] op_sel:[0,0,0] op_sel_hi:[1,1,0] neg_lo:[1,0,1] neg_hi:[1,0,1]
    v_pk_fma_f32 v[142:143], v[34:35], s[68:69], v[136:137] op_sel:[0,0,0] op_sel_hi:[1,1,0] neg_lo:[0,0,1] neg_hi:[0,0,1]
    v_pk_fma_f32 v[146:147], v[34:35], s[68:69], v[138:139] op_sel:[0,0,0] op_sel_hi:[1,1,0] neg_lo:[1,0,1] neg_hi:[1,0,1]
    v_pk_fma_f32 v[148:149], v[36:37], s[68:69], v[136:137] op_sel:[0,0,1] op_sel_hi:[1,1,1] neg_lo:[0,0,1] neg_hi:[0,0,1]
    v_pk_fma_f32 v[152:153], v[36:37], s[68:69], v[138:139] op_sel:[0,0,1] op_sel_hi:[1,1,1] neg_lo:[1,0,1] neg_hi:[1,0,1]
    v_pk_fma_f32 v[150:151], v[38:39], s[68:69], v[136:137] op_sel:[0,0,1] op_sel_hi:[1,1,1] neg_lo:[0,0,1] neg_hi:[0,0,1]
    v_pk_fma_f32 v[154:155], v[38:39], s[68:69], v[138:139] op_sel:[0,0,1] op_sel_hi:[1,1,1] neg_lo:[1,0,1] neg_hi:[1,0,1]
    v_exp_f32 v140, v140
    v_exp_f32 v141, v141
    v_exp_f32 v142, v142
    v_exp_f32 v143, v143
    v_exp_f32 v144, v144
    v_exp_f32 v145, v145
    v_exp_f32 v146, v146
    v_exp_f32 v147, v147
    v_exp_f32 v148, v148
    v_exp_f32 v149, v149
    v_exp_f32 v150, v150
    v_exp_f32 v151, v151
    v_exp_f32 v152, v152
    v_exp_f32 v153, v153
    v_exp_f32 v154, v154
    v_exp_f32 v155, v155
    v_cvt_pk_bf16_f32 v132, v40, v41
    v_cvt_pk_bf16_f32 v133, v42, v43
    v_pk_add_f32 v[88:89], v[140:141], v[142:143]
    v_add_f32 v136, v88, v89
    v_pk_add_f32 v[90:91], v[144:145], v[146:147]
    v_add_f32 v138, v90, v91
    v_pk_add_f32 v[88:89], v[148:149], v[150:151]
    v_add_f32 v137, v88, v89
    v_pk_add_f32 v[90:91], v[152:153], v[154:155]
    v_add_f32 v139, v90, v91
    s_nop 1
    v_permlane32_swap_b32 v136, v137
    v_permlane32_swap_b32 v138, v139
    s_nop 0
    v_add_f32 v136, v136, v137
    v_add_f32 v138, v138, v139
    s_nop 1
    v_permlane16_swap_b32 v136, v138
    s_nop 0
    v_add_f32 v136, v136, v138
    v_rcp_f32 v136, v136
    v_lshl_add_u32 v95, v106, 11, v94
    v_mov_b32 v138, v136
    s_nop 1
    v_permlane16_swap_b32 v136, v138
    s_nop 0
    v_mov_b32 v137, v136
    v_mov_b32 v139, v138
    s_nop 1
    v_permlane32_swap_b32 v136, v137
    v_permlane32_swap_b32 v138, v139
    s_nop 0
    v_pk_mul_f32 v[140:141], v[140:141], v[136:137] op_sel:[0,0] op_sel_hi:[1,0]
    v_pk_mul_f32 v[142:143], v[142:143], v[136:137] op_sel:[0,0] op_sel_hi:[1,0]
    v_pk_mul_f32 v[144:145], v[144:145], v[138:139] op_sel:[0,0] op_sel_hi:[1,0]
    v_pk_mul_f32 v[146:147], v[146:147], v[138:139] op_sel:[0,0] op_sel_hi:[1,0]
    v_pk_mul_f32 v[148:149], v[148:149], v[136:137] op_sel:[0,1] op_sel_hi:[1,1]
    v_pk_mul_f32 v[150:151], v[150:151], v[136:137] op_sel:[0,1] op_sel_hi:[1,1]
    v_pk_mul_f32 v[152:153], v[152:153], v[138:139] op_sel:[0,1] op_sel_hi:[1,1]
    v_pk_mul_f32 v[154:155], v[154:155], v[138:139] op_sel:[0,1] op_sel_hi:[1,1]
    v_cvt_pk_bf16_f32 v32, v140, v141
    v_cvt_pk_bf16_f32 v33, v142, v143
    v_cvt_pk_bf16_f32 v124, v148, v149
    v_cvt_pk_bf16_f32 v125, v150, v151
    v_cvt_pk_bf16_f32 v34, v144, v145
    v_cvt_pk_bf16_f32 v35, v146, v147
    v_cvt_pk_bf16_f32 v126, v152, v153
    v_cvt_pk_bf16_f32 v127, v154, v155
    buffer_store_dwordx4 v[32:35], v95, s[28:31], 0 offen
    s_nop 0
    v_mfma_f32_16x16x16_bf16 v[156:159], v[124:125], v[84:85], 0
    v_mfma_f32_16x16x16_bf16 v[160:163], v[126:127], v[84:85], 0
    s_nop 7
    v_cvt_pk_bf16_f32 v128, v156, v157
    v_cvt_pk_bf16_f32 v129, v158, v159
    v_cvt_pk_bf16_f32 v130, v160, v161
    v_cvt_pk_bf16_f32 v131, v162, v163
    s_nop 1
    v_mfma_f32_16x16x16_bf16 v[108:111], v[128:129], v[132:133], v[108:111]
    v_mfma_f32_16x16x16_bf16 v[116:119], v[128:129], v[68:69], v[116:119]
    v_mfma_f32_16x16x16_bf16 v[112:115], v[130:131], v[132:133], v[112:115]
    v_mfma_f32_16x16x16_bf16 v[120:123], v[130:131], v[68:69], v[120:123]
    v_max3_f32 v136, v44, v45, v46
    v_max3_f32 v138, -v44, -v45, -v46
    v_max_f32 v136, v136, v47
    v_max_f32_e64 v138, v138, -v47
    v_max3_f32 v137, v48, v49, v50
    v_max3_f32 v139, -v48, -v49, -v50
    v_max_f32 v137, v137, v51
    v_max_f32_e64 v139, v139, -v51
    s_nop 1
    v_permlane32_swap_b32 v136, v137
    v_permlane32_swap_b32 v138, v139
    s_nop 0
    v_max_f32 v136, v136, v137
    v_max_f32 v138, v138, v139
    s_nop 1
    v_permlane16_swap_b32 v136, v138
    s_nop 0
    v_max_f32 v136, v136, v138
    v_mul_f32 v136, s53, v136
    v_mov_b32 v138, v136
    s_nop 1
    v_permlane16_swap_b32 v136, v138
    s_nop 0
    v_mov_b32 v137, v136
    v_mov_b32 v139, v138
    s_nop 1
    v_permlane32_swap_b32 v136, v137
    v_permlane32_swap_b32 v138, v139
    s_nop 0
    v_pk_fma_f32 v[140:141], v[44:45], s[68:69], v[136:137] op_sel:[0,0,0] op_sel_hi:[1,1,0] neg_lo:[0,0,1] neg_hi:[0,0,1]
    v_pk_fma_f32 v[144:145], v[44:45], s[68:69], v[138:139] op_sel:[0,0,0] op_sel_hi:[1,1,0] neg_lo:[1,0,1] neg_hi:[1,0,1]
    v_pk_fma_f32 v[142:143], v[46:47], s[68:69], v[136:137] op_sel:[0,0,0] op_sel_hi:[1,1,0] neg_lo:[0,0,1] neg_hi:[0,0,1]
    v_pk_fma_f32 v[146:147], v[46:47], s[68:69], v[138:139] op_sel:[0,0,0] op_sel_hi:[1,1,0] neg_lo:[1,0,1] neg_hi:[1,0,1]
    v_pk_fma_f32 v[148:149], v[48:49], s[68:69], v[136:137] op_sel:[0,0,1] op_sel_hi:[1,1,1] neg_lo:[0,0,1] neg_hi:[0,0,1]
    v_pk_fma_f32 v[152:153], v[48:49], s[68:69], v[138:139] op_sel:[0,0,1] op_sel_hi:[1,1,1] neg_lo:[1,0,1] neg_hi:[1,0,1]
    v_pk_fma_f32 v[150:151], v[50:51], s[68:69], v[136:137] op_sel:[0,0,1] op_sel_hi:[1,1,1] neg_lo:[0,0,1] neg_hi:[0,0,1]
    v_pk_fma_f32 v[154:155], v[50:51], s[68:69], v[138:139] op_sel:[0,0,1] op_sel_hi:[1,1,1] neg_lo:[1,0,1] neg_hi:[1,0,1]
    v_exp_f32 v140, v140
    v_exp_f32 v141, v141
    v_exp_f32 v142, v142
    v_exp_f32 v143, v143
    v_exp_f32 v144, v144
    v_exp_f32 v145, v145
    v_exp_f32 v146, v146
    v_exp_f32 v147, v147
    v_exp_f32 v148, v148
    v_exp_f32 v149, v149
    v_exp_f32 v150, v150
    v_exp_f32 v151, v151
    v_exp_f32 v152, v152
    v_exp_f32 v153, v153
    v_exp_f32 v154, v154
    v_exp_f32 v155, v155
    v_cvt_pk_bf16_f32 v132, v52, v53
    v_cvt_pk_bf16_f32 v133, v54, v55
    v_pk_add_f32 v[88:89], v[140:141], v[142:143]
    v_add_f32 v136, v88, v89
    v_pk_add_f32 v[90:91], v[144:145], v[146:147]
    v_add_f32 v138, v90, v91
    v_pk_add_f32 v[88:89], v[148:149], v[150:151]
    v_add_f32 v137, v88, v89
    v_pk_add_f32 v[90:91], v[152:153], v[154:155]
    v_add_f32 v139, v90, v91
    s_nop 1
    v_permlane32_swap_b32 v136, v137
    v_permlane32_swap_b32 v138, v139
    s_nop 0
    v_add_f32 v136, v136, v137
    v_add_f32 v138, v138, v139
    s_nop 1
    v_permlane16_swap_b32 v136, v138
    s_nop 0
    v_add_f32 v136, v136, v138
    v_rcp_f32 v136, v136
    v_lshl_add_u32 v95, v107, 11, v94
    v_mov_b32 v138, v136
    s_nop 1
    v_permlane16_swap_b32 v136, v138
    s_nop 0
    v_mov_b32 v137, v136
    v_mov_b32 v139, v138
    s_nop 1
    v_permlane32_swap_b32 v136, v137
    v_permlane32_swap_b32 v138, v139
    s_nop 0
    v_pk_mul_f32 v[140:141], v[140:141], v[136:137] op_sel:[0,0] op_sel_hi:[1,0]
    v_pk_mul_f32 v[142:143], v[142:143], v[136:137] op_sel:[0,0] op_sel_hi:[1,0]
    v_pk_mul_f32 v[144:145], v[144:145], v[138:139] op_sel:[0,0] op_sel_hi:[1,0]
    v_pk_mul_f32 v[146:147], v[146:147], v[138:139] op_sel:[0,0] op_sel_hi:[1,0]
    v_pk_mul_f32 v[148:149], v[148:149], v[136:137] op_sel:[0,1] op_sel_hi:[1,1]
    v_pk_mul_f32 v[150:151], v[150:151], v[136:137] op_sel:[0,1] op_sel_hi:[1,1]
    v_pk_mul_f32 v[152:153], v[152:153], v[138:139] op_sel:[0,1] op_sel_hi:[1,1]
    v_pk_mul_f32 v[154:155], v[154:155], v[138:139] op_sel:[0,1] op_sel_hi:[1,1]
    v_cvt_pk_bf16_f32 v44, v140, v141
    v_cvt_pk_bf16_f32 v45, v142, v143
    v_cvt_pk_bf16_f32 v124, v148, v149
    v_cvt_pk_bf16_f32 v125, v150, v151
    v_cvt_pk_bf16_f32 v46, v144, v145
    v_cvt_pk_bf16_f32 v47, v146, v147
    v_cvt_pk_bf16_f32 v126, v152, v153
    v_cvt_pk_bf16_f32 v127, v154, v155
    buffer_store_dwordx4 v[44:47], v95, s[28:31], 0 offen
    s_nop 0
    v_mfma_f32_16x16x16_bf16 v[156:159], v[124:125], v[84:85], 0
    v_mfma_f32_16x16x16_bf16 v[160:163], v[126:127], v[84:85], 0
    s_nop 7
    v_cvt_pk_bf16_f32 v128, v156, v157
    v_cvt_pk_bf16_f32 v129, v158, v159
    v_cvt_pk_bf16_f32 v130, v160, v161
    v_cvt_pk_bf16_f32 v131, v162, v163
    s_nop 1
    v_mfma_f32_16x16x16_bf16 v[108:111], v[128:129], v[132:133], v[108:111]
    v_mfma_f32_16x16x16_bf16 v[116:119], v[128:129], v[68:69], v[116:119]
    v_mfma_f32_16x16x16_bf16 v[112:115], v[130:131], v[132:133], v[112:115]
    v_mfma_f32_16x16x16_bf16 v[120:123], v[130:131], v[68:69], v[120:123]
    s_lshl_b32 s46, s63, 12
    v_lshlrev_b32 v88, 4, v1
    v_add_u32 v88, s46, v88
    s_cmp_eq_u32 s64, 0
    s_cbranch_scc1 L_k1_kv0
    s_nop 4
    ds_write_b128 v88, v[108:111] offset:0
    ds_write_b128 v88, v[112:115] offset:1024
    ds_write_b128 v88, v[116:119] offset:2048
    ds_write_b128 v88, v[120:123] offset:3072
    s_waitcnt lgkmcnt(0)
    s_barrier
    s_endpgm
L_k1_kv0:
    s_lshl_b32 s46, s47, 5
    s_add_u32 s3, s3, s46
    s_lshl_b32 s46, s3, 11
    s_lshl_b32 s3, s3, 7
    s_add_u32 s3, s3, 1048576
    s_barrier
    ds_read_b128 v[140:143], v88 offset:0
    ds_read_b128 v[144:147], v88 offset:1024
    ds_read_b128 v[148:151], v88 offset:2048
    ds_read_b128 v[152:155], v88 offset:3072
    v_lshlrev_b32 v88, 5, v1
    v_lshlrev_b32 v89, 5, v2
    s_waitcnt lgkmcnt(0)
    v_add_f32 v108, v108, v140
    v_add_f32 v109, v109, v141
    v_add_f32 v110, v110, v142
    v_add_f32 v111, v111, v143
    v_add_f32 v112, v112, v144
    v_add_f32 v113, v113, v145
    v_add_f32 v114, v114, v146
    v_add_f32 v115, v115, v147
    v_add_f32 v116, v116, v148
    v_add_f32 v117, v117, v149
    v_add_f32 v118, v118, v150
    v_add_f32 v119, v119, v151
    v_add_f32 v120, v120, v152
    v_add_f32 v121, v121, v153
    v_add_f32 v122, v122, v154
    v_add_f32 v123, v123, v155
    buffer_store_dwordx4 v[108:111], v88, s[32:35], s46 offen
    buffer_store_dwordx4 v[112:115], v88, s[32:35], s46 offen offset:16
    v_cmp_eq_u32 vcc, 0, v3
    s_and_saveexec_b64 s[36:37], vcc
    buffer_store_dwordx4 v[116:119], v89, s[32:35], s3 offen
    buffer_store_dwordx4 v[120:123], v89, s[32:35], s3 offen offset:16
    s_endpgm
L_k1_z:
    v_mov_b32 v95, 3222493025
    v_mov_b32 v94, 3184710632
    v_mov_b32 v92, 1.0
    s_cmp_eq_u32 s55, 3
    s_cselect_b32 s62, 2, 3
    v_pk_mul_f32 v[88:89], v[8:9], v[8:9]
    v_pk_mul_f32 v[90:91], v[10:11], v[10:11]
    v_pk_fma_f32 v[88:89], v[88:89], v[94:95], v[94:95] op_sel:[0,0,1] op_sel_hi:[1,0,1]
    v_pk_fma_f32 v[90:91], v[90:91], v[94:95], v[94:95] op_sel:[0,0,1] op_sel_hi:[1,0,1]
    v_pk_mul_f32 v[88:89], v[88:89], v[8:9]
    v_pk_mul_f32 v[90:91], v[90:91], v[10:11]
    v_exp_f32 v88, v88
    v_exp_f32 v89, v89
    v_exp_f32 v90, v90
    v_exp_f32 v91, v91
    v_pk_add_f32 v[88:89], v[88:89], v[92:93] op_sel:[0,0] op_sel_hi:[1,0]
    v_pk_add_f32 v[90:91], v[90:91], v[92:93] op_sel:[0,0] op_sel_hi:[1,0]
    v_rcp_f32 v88, v88
    v_rcp_f32 v89, v89
    v_rcp_f32 v90, v90
    v_rcp_f32 v91, v91
    v_pk_mul_f32 v[8:9], v[88:89], v[8:9]
    v_pk_mul_f32 v[10:11], v[90:91], v[10:11]
    v_pk_mul_f32 v[88:89], v[12:13], v[12:13]
    v_pk_mul_f32 v[90:91], v[14:15], v[14:15]
    v_pk_fma_f32 v[88:89], v[88:89], v[94:95], v[94:95] op_sel:[0,0,1] op_sel_hi:[1,0,1]
    v_pk_fma_f32 v[90:91], v[90:91], v[94:95], v[94:95] op_sel:[0,0,1] op_sel_hi:[1,0,1]
    v_pk_mul_f32 v[88:89], v[88:89], v[12:13]
    v_pk_mul_f32 v[90:91], v[90:91], v[14:15]
    v_exp_f32 v88, v88
    v_exp_f32 v89, v89
    v_exp_f32 v90, v90
    v_exp_f32 v91, v91
    v_pk_add_f32 v[88:89], v[88:89], v[92:93] op_sel:[0,0] op_sel_hi:[1,0]
    v_pk_add_f32 v[90:91], v[90:91], v[92:93] op_sel:[0,0] op_sel_hi:[1,0]
    v_rcp_f32 v88, v88
    v_rcp_f32 v89, v89
    v_rcp_f32 v90, v90
    v_rcp_f32 v91, v91
    v_pk_mul_f32 v[12:13], v[88:89], v[12:13]
    v_pk_mul_f32 v[14:15], v[90:91], v[14:15]
    v_pk_mul_f32 v[88:89], v[16:17], v[16:17]
    v_pk_mul_f32 v[90:91], v[18:19], v[18:19]
    v_pk_fma_f32 v[88:89], v[88:89], v[94:95], v[94:95] op_sel:[0,0,1] op_sel_hi:[1,0,1]
    v_pk_fma_f32 v[90:91], v[90:91], v[94:95], v[94:95] op_sel:[0,0,1] op_sel_hi:[1,0,1]
    v_pk_mul_f32 v[88:89], v[88:89], v[16:17]
    v_pk_mul_f32 v[90:91], v[90:91], v[18:19]
    v_exp_f32 v88, v88
    v_exp_f32 v89, v89
    v_exp_f32 v90, v90
    v_exp_f32 v91, v91
    v_pk_add_f32 v[88:89], v[88:89], v[92:93] op_sel:[0,0] op_sel_hi:[1,0]
    v_pk_add_f32 v[90:91], v[90:91], v[92:93] op_sel:[0,0] op_sel_hi:[1,0]
    v_rcp_f32 v88, v88
    v_rcp_f32 v89, v89
    v_rcp_f32 v90, v90
    v_rcp_f32 v91, v91
    v_pk_mul_f32 v[16:17], v[88:89], v[16:17]
    v_pk_mul_f32 v[18:19], v[90:91], v[18:19]
    v_pk_mul_f32 v[88:89], v[20:21], v[20:21]
    v_pk_mul_f32 v[90:91], v[22:23], v[22:23]
    v_pk_fma_f32 v[88:89], v[88:89], v[94:95], v[94:95] op_sel:[0,0,1] op_sel_hi:[1,0,1]
    v_pk_fma_f32 v[90:91], v[90:91], v[94:95], v[94:95] op_sel:[0,0,1] op_sel_hi:[1,0,1]
    v_pk_mul_f32 v[88:89], v[88:89], v[20:21]
    v_pk_mul_f32 v[90:91], v[90:91], v[22:23]
    v_exp_f32 v88, v88
    v_exp_f32 v89, v89
    v_exp_f32 v90, v90
    v_exp_f32 v91, v91
    v_pk_add_f32 v[88:89], v[88:89], v[92:93] op_sel:[0,0] op_sel_hi:[1,0]
    v_pk_add_f32 v[90:91], v[90:91], v[92:93] op_sel:[0,0] op_sel_hi:[1,0]
    v_rcp_f32 v88, v88
    v_rcp_f32 v89, v89
    v_rcp_f32 v90, v90
    v_rcp_f32 v91, v91
    v_pk_mul_f32 v[20:21], v[88:89], v[20:21]
    v_pk_mul_f32 v[22:23], v[90:91], v[22:23]
    v_pk_mul_f32 v[88:89], v[24:25], v[24:25]
    v_pk_mul_f32 v[90:91], v[26:27], v[26:27]
    v_pk_fma_f32 v[88:89], v[88:89], v[94:95], v[94:95] op_sel:[0,0,1] op_sel_hi:[1,0,1]
    v_pk_fma_f32 v[90:91], v[90:91], v[94:95], v[94:95] op_sel:[0,0,1] op_sel_hi:[1,0,1]
    v_pk_mul_f32 v[88:89], v[88:89], v[24:25]
    v_pk_mul_f32 v[90:91], v[90:91], v[26:27]
    v_exp_f32 v88, v88
    v_exp_f32 v89, v89
    v_exp_f32 v90, v90
    v_exp_f32 v91, v91
    v_pk_add_f32 v[88:89], v[88:89], v[92:93] op_sel:[0,0] op_sel_hi:[1,0]
    v_pk_add_f32 v[90:91], v[90:91], v[92:93] op_sel:[0,0] op_sel_hi:[1,0]
    v_rcp_f32 v88, v88
    v_rcp_f32 v89, v89
    v_rcp_f32 v90, v90
    v_rcp_f32 v91, v91
    v_pk_mul_f32 v[24:25], v[88:89], v[24:25]
    v_pk_mul_f32 v[26:27], v[90:91], v[26:27]
    v_pk_mul_f32 v[88:89], v[28:29], v[28:29]
    v_pk_mul_f32 v[90:91], v[30:31], v[30:31]
    v_pk_fma_f32 v[88:89], v[88:89], v[94:95], v[94:95] op_sel:[0,0,1] op_sel_hi:[1,0,1]
    v_pk_fma_f32 v[90:91], v[90:91], v[94:95], v[94:95] op_sel:[0,0,1] op_sel_hi:[1,0,1]
    v_pk_mul_f32 v[88:89], v[88:89], v[28:29]
    v_pk_mul_f32 v[90:91], v[90:91], v[30:31]
    v_exp_f32 v88, v88
    v_exp_f32 v89, v89
    v_exp_f32 v90, v90
    v_exp_f32 v91, v91
    v_pk_add_f32 v[88:89], v[88:89], v[92:93] op_sel:[0,0] op_sel_hi:[1,0]
    v_pk_add_f32 v[90:91], v[90:91], v[92:93] op_sel:[0,0] op_sel_hi:[1,0]
    v_rcp_f32 v88, v88
    v_rcp_f32 v89, v89
    v_rcp_f32 v90, v90
    v_rcp_f32 v91, v91
    v_pk_mul_f32 v[28:29], v[88:89], v[28:29]
    v_pk_mul_f32 v[30:31], v[90:91], v[30:31]
    v_pk_mul_f32 v[88:89], v[32:33], v[32:33]
    v_pk_mul_f32 v[90:91], v[34:35], v[34:35]
    v_pk_fma_f32 v[88:89], v[88:89], v[94:95], v[94:95] op_sel:[0,0,1] op_sel_hi:[1,0,1]
    v_pk_fma_f32 v[90:91], v[90:91], v[94:95], v[94:95] op_sel:[0,0,1] op_sel_hi:[1,0,1]
    v_pk_mul_f32 v[88:89], v[88:89], v[32:33]
    v_pk_mul_f32 v[90:91], v[90:91], v[34:35]
    v_exp_f32 v88, v88
    v_exp_f32 v89, v89
    v_exp_f32 v90, v90
    v_exp_f32 v91, v91
    v_pk_add_f32 v[88:89], v[88:89], v[92:93] op_sel:[0,0] op_sel_hi:[1,0]
    v_pk_add_f32 v[90:91], v[90:91], v[92:93] op_sel:[0,0] op_sel_hi:[1,0]
    v_rcp_f32 v88, v88
    v_rcp_f32 v89, v89
    v_rcp_f32 v90, v90
    v_rcp_f32 v91, v91
    v_pk_mul_f32 v[32:33], v[88:89], v[32:33]
    v_pk_mul_f32 v[34:35], v[90:91], v[34:35]
    v_pk_mul_f32 v[88:89], v[36:37], v[36:37]
    v_pk_mul_f32 v[90:91], v[38:39], v[38:39]
    v_pk_fma_f32 v[88:89], v[88:89], v[94:95], v[94:95] op_sel:[0,0,1] op_sel_hi:[1,0,1]
    v_pk_fma_f32 v[90:91], v[90:91], v[94:95], v[94:95] op_sel:[0,0,1] op_sel_hi:[1,0,1]
    v_pk_mul_f32 v[88:89], v[88:89], v[36:37]
    v_pk_mul_f32 v[90:91], v[90:91], v[38:39]
    v_exp_f32 v88, v88
    v_exp_f32 v89, v89
    v_exp_f32 v90, v90
    v_exp_f32 v91, v91
    v_pk_add_f32 v[88:89], v[88:89], v[92:93] op_sel:[0,0] op_sel_hi:[1,0]
    v_pk_add_f32 v[90:91], v[90:91], v[92:93] op_sel:[0,0] op_sel_hi:[1,0]
    v_rcp_f32 v88, v88
    v_rcp_f32 v89, v89
    v_rcp_f32 v90, v90
    v_rcp_f32 v91, v91
    v_pk_mul_f32 v[36:37], v[88:89], v[36:37]
    v_pk_mul_f32 v[38:39], v[90:91], v[38:39]
    v_pk_mul_f32 v[88:89], v[40:41], v[40:41]
    v_pk_mul_f32 v[90:91], v[42:43], v[42:43]
    v_pk_fma_f32 v[88:89], v[88:89], v[94:95], v[94:95] op_sel:[0,0,1] op_sel_hi:[1,0,1]
    v_pk_fma_f32 v[90:91], v[90:91], v[94:95], v[94:95] op_sel:[0,0,1] op_sel_hi:[1,0,1]
    v_pk_mul_f32 v[88:89], v[88:89], v[40:41]
    v_pk_mul_f32 v[90:91], v[90:91], v[42:43]
    v_exp_f32 v88, v88
    v_exp_f32 v89, v89
    v_exp_f32 v90, v90
    v_exp_f32 v91, v91
    v_pk_add_f32 v[88:89], v[88:89], v[92:93] op_sel:[0,0] op_sel_hi:[1,0]
    v_pk_add_f32 v[90:91], v[90:91], v[92:93] op_sel:[0,0] op_sel_hi:[1,0]
    v_rcp_f32 v88, v88
    v_rcp_f32 v89, v89
    v_rcp_f32 v90, v90
    v_rcp_f32 v91, v91
    v_pk_mul_f32 v[40:41], v[88:89], v[40:41]
    v_pk_mul_f32 v[42:43], v[90:91], v[42:43]
    v_pk_mul_f32 v[88:89], v[44:45], v[44:45]
    v_pk_mul_f32 v[90:91], v[46:47], v[46:47]
    v_pk_fma_f32 v[88:89], v[88:89], v[94:95], v[94:95] op_sel:[0,0,1] op_sel_hi:[1,0,1]
    v_pk_fma_f32 v[90:91], v[90:91], v[94:95], v[94:95] op_sel:[0,0,1] op_sel_hi:[1,0,1]
    v_pk_mul_f32 v[88:89], v[88:89], v[44:45]
    v_pk_mul_f32 v[90:91], v[90:91], v[46:47]
    v_exp_f32 v88, v88
    v_exp_f32 v89, v89
    v_exp_f32 v90, v90
    v_exp_f32 v91, v91
    v_pk_add_f32 v[88:89], v[88:89], v[92:93] op_sel:[0,0] op_sel_hi:[1,0]
    v_pk_add_f32 v[90:91], v[90:91], v[92:93] op_sel:[0,0] op_sel_hi:[1,0]
    v_rcp_f32 v88, v88
    v_rcp_f32 v89, v89
    v_rcp_f32 v90, v90
    v_rcp_f32 v91, v91
    v_pk_mul_f32 v[44:45], v[88:89], v[44:45]
    v_pk_mul_f32 v[46:47], v[90:91], v[46:47]
    v_pk_mul_f32 v[88:89], v[48:49], v[48:49]
    v_pk_mul_f32 v[90:91], v[50:51], v[50:51]
    v_pk_fma_f32 v[88:89], v[88:89], v[94:95], v[94:95] op_sel:[0,0,1] op_sel_hi:[1,0,1]
    v_pk_fma_f32 v[90:91], v[90:91], v[94:95], v[94:95] op_sel:[0,0,1] op_sel_hi:[1,0,1]
    v_pk_mul_f32 v[88:89], v[88:89], v[48:49]
    v_pk_mul_f32 v[90:91], v[90:91], v[50:51]
    v_exp_f32 v88, v88
    v_exp_f32 v89, v89
    v_exp_f32 v90, v90
    v_exp_f32 v91, v91
    v_pk_add_f32 v[88:89], v[88:89], v[92:93] op_sel:[0,0] op_sel_hi:[1,0]
    v_pk_add_f32 v[90:91], v[90:91], v[92:93] op_sel:[0,0] op_sel_hi:[1,0]
    v_rcp_f32 v88, v88
    v_rcp_f32 v89, v89
    v_rcp_f32 v90, v90
    v_rcp_f32 v91, v91
    v_pk_mul_f32 v[48:49], v[88:89], v[48:49]
    v_pk_mul_f32 v[50:51], v[90:91], v[50:51]
    v_pk_mul_f32 v[88:89], v[52:53], v[52:53]
    v_pk_mul_f32 v[90:91], v[54:55], v[54:55]
    v_pk_fma_f32 v[88:89], v[88:89], v[94:95], v[94:95] op_sel:[0,0,1] op_sel_hi:[1,0,1]
    v_pk_fma_f32 v[90:91], v[90:91], v[94:95], v[94:95] op_sel:[0,0,1] op_sel_hi:[1,0,1]
    v_pk_mul_f32 v[88:89], v[88:89], v[52:53]
    v_pk_mul_f32 v[90:91], v[90:91], v[54:55]
    v_exp_f32 v88, v88
    v_exp_f32 v89, v89
    v_exp_f32 v90, v90
    v_exp_f32 v91, v91
    v_pk_add_f32 v[88:89], v[88:89], v[92:93] op_sel:[0,0] op_sel_hi:[1,0]
    v_pk_add_f32 v[90:91], v[90:91], v[92:93] op_sel:[0,0] op_sel_hi:[1,0]
    v_rcp_f32 v88, v88
    v_rcp_f32 v89, v89
    v_rcp_f32 v90, v90
    v_rcp_f32 v91, v91
    v_pk_mul_f32 v[52:53], v[88:89], v[52:53]
    v_pk_mul_f32 v[54:55], v[90:91], v[54:55]
    s_mul_i32 s52, s55, 176
    s_lshl_b32 s3, s63, 4
    s_add_u32 s52, s52, s3
    s_bitcmp1_b32 s48, 2
    s_cbranch_scc1 L_k1_z2
    s_add_u32 s28, s12, 4194304
    s_addc_u32 s29, s13, 0
    s_mov_b32 s30, 2883584
    s_mov_b32 s31, 0x00020000
    s_lshl_b32 s3, s52, 1
    v_lshrrev_b32 v94, 1, v2
    v_lshlrev_b32 v94, 4, v94
    v_add_u32 v94, s3, v94
    s_mov_b32 s3, 1408
    v_and_b32 v93, 1, v2
    v_cmp_eq_u32 vcc, 1, v93
    s_nop 1
    v_cndmask_b32 v104, v104, v105, vcc
    v_mad_u32_u24 v104, v104, s3, v94
    v_cndmask_b32 v106, v106, v107, vcc
    v_mad_u32_u24 v106, v106, s3, v94
    v_cvt_pk_bf16_f32 v8, v8, v9
    v_cvt_pk_bf16_f32 v9, v10, v11
    v_cvt_pk_bf16_f32 v10, v20, v21
    v_cvt_pk_bf16_f32 v11, v22, v23
    v_cvt_pk_bf16_f32 v32, v32, v33
    v_cvt_pk_bf16_f32 v33, v34, v35
    v_cvt_pk_bf16_f32 v34, v44, v45
    v_cvt_pk_bf16_f32 v35, v46, v47
    s_nop 1
    v_permlane16_swap_b32 v8, v10
    v_permlane16_swap_b32 v9, v11
    v_permlane16_swap_b32 v32, v34
    v_permlane16_swap_b32 v33, v35
    s_nop 0
    buffer_store_dwordx4 v[8:11], v104, s[28:31], 0 offen offset:0
    buffer_store_dwordx4 v[32:35], v106, s[28:31], 0 offen offset:0
    v_cvt_pk_bf16_f32 v12, v12, v13
    v_cvt_pk_bf16_f32 v13, v14, v15
    v_cvt_pk_bf16_f32 v14, v24, v25
    v_cvt_pk_bf16_f32 v15, v26, v27
    v_cvt_pk_bf16_f32 v36, v36, v37
    v_cvt_pk_bf16_f32 v37, v38, v39
    v_cvt_pk_bf16_f32 v38, v48, v49
    v_cvt_pk_bf16_f32 v39, v50, v51
    s_nop 1
    v_permlane16_swap_b32 v12, v14
    v_permlane16_swap_b32 v13, v15
    v_permlane16_swap_b32 v36, v38
    v_permlane16_swap_b32 v37, v39
    s_nop 0
    buffer_store_dwordx4 v[12:15], v104, s[28:31], 0 offen offset:128
    buffer_store_dwordx4 v[36:39], v106, s[28:31], 0 offen offset:128
    s_cmp_ge_u32 s63, s62
    s_cbranch_scc1 L_k1_end
    v_cvt_pk_bf16_f32 v16, v16, v17
    v_cvt_pk_bf16_f32 v17, v18, v19
    v_cvt_pk_bf16_f32 v18, v28, v29
    v_cvt_pk_bf16_f32 v19, v30, v31
    v_cvt_pk_bf16_f32 v40, v40, v41
    v_cvt_pk_bf16_f32 v41, v42, v43
    v_cvt_pk_bf16_f32 v42, v52, v53
    v_cvt_pk_bf16_f32 v43, v54, v55
    s_nop 1
    v_permlane16_swap_b32 v16, v18
    v_permlane16_swap_b32 v17, v19
    v_permlane16_swap_b32 v40, v42
    v_permlane16_swap_b32 v41, v43
    s_nop 0
    buffer_store_dwordx4 v[16:19], v104, s[28:31], 0 offen offset:256
    buffer_store_dwordx4 v[40:43], v106, s[28:31], 0 offen offset:256
    s_endpgm
L_k1_z2:
    s_add_u32 s28, s12, 8388608
    s_addc_u32 s29, s13, 0
    s_mov_b32 s30, 2818048
    s_mov_b32 s31, 0x00020000
    s_add_u32 s32, s12, 16777216
    s_addc_u32 s33, s13, 0
    s_mov_b32 s34, 65536
    s_mov_b32 s35, 0x00020000
    s_cmp_lt_u32 s63, s62
    s_cbranch_scc1 L_k1_z2v
    v_mov_b32 v16, 0
    v_mov_b32 v17, 0
    v_mov_b32 v18, 0
    v_mov_b32 v19, 0
    v_mov_b32 v28, 0
    v_mov_b32 v29, 0
    v_mov_b32 v30, 0
    v_mov_b32 v31, 0
    v_mov_b32 v40, 0
    v_mov_b32 v41, 0
    v_mov_b32 v42, 0
    v_mov_b32 v43, 0
    v_mov_b32 v52, 0
    v_mov_b32 v53, 0
    v_mov_b32 v54, 0
    v_mov_b32 v55, 0
L_k1_z2v:
    v_pk_add_f32 v[88:89], v[8:9], v[10:11]
    v_pk_mul_f32 v[90:91], v[8:9], v[8:9]
    v_pk_add_f32 v[88:89], v[88:89], v[12:13]
    v_pk_add_f32 v[88:89], v[88:89], v[14:15]
    v_pk_add_f32 v[88:89], v[88:89], v[16:17]
    v_pk_add_f32 v[88:89], v[88:89], v[18:19]
    v_pk_fma_f32 v[90:91], v[10:11], v[10:11], v[90:91]
    v_pk_fma_f32 v[90:91], v[12:13], v[12:13], v[90:91]
    v_pk_fma_f32 v[90:91], v[14:15], v[14:15], v[90:91]
    v_pk_fma_f32 v[90:91], v[16:17], v[16:17], v[90:91]
    v_pk_fma_f32 v[90:91], v[18:19], v[18:19], v[90:91]
    v_add_f32 v96, v88, v89
    v_add_f32 v97, v90, v91
    v_pk_add_f32 v[88:89], v[20:21], v[22:23]
    v_pk_mul_f32 v[90:91], v[20:21], v[20:21]
    v_pk_add_f32 v[88:89], v[88:89], v[24:25]
    v_pk_add_f32 v[88:89], v[88:89], v[26:27]
    v_pk_add_f32 v[88:89], v[88:89], v[28:29]
    v_pk_add_f32 v[88:89], v[88:89], v[30:31]
    v_pk_fma_f32 v[90:91], v[22:23], v[22:23], v[90:91]
    v_pk_fma_f32 v[90:91], v[24:25], v[24:25], v[90:91]
    v_pk_fma_f32 v[90:91], v[26:27], v[26:27], v[90:91]
    v_pk_fma_f32 v[90:91], v[28:29], v[28:29], v[90:91]
    v_pk_fma_f32 v[90:91], v[30:31], v[30:31], v[90:91]
    v_add_f32 v98, v88, v89
    v_add_f32 v99, v90, v91
    v_pk_add_f32 v[88:89], v[32:33], v[34:35]
    v_pk_mul_f32 v[90:91], v[32:33], v[32:33]
    v_pk_add_f32 v[88:89], v[88:89], v[36:37]
    v_pk_add_f32 v[88:89], v[88:89], v[38:39]
    v_pk_add_f32 v[88:89], v[88:89], v[40:41]
    v_pk_add_f32 v[88:89], v[88:89], v[42:43]
    v_pk_fma_f32 v[90:91], v[34:35], v[34:35], v[90:91]
    v_pk_fma_f32 v[90:91], v[36:37], v[36:37], v[90:91]
    v_pk_fma_f32 v[90:91], v[38:39], v[38:39], v[90:91]
    v_pk_fma_f32 v[90:91], v[40:41], v[40:41], v[90:91]
    v_pk_fma_f32 v[90:91], v[42:43], v[42:43], v[90:91]
    v_add_f32 v100, v88, v89
    v_add_f32 v101, v90, v91
    v_pk_add_f32 v[88:89], v[44:45], v[46:47]
    v_pk_mul_f32 v[90:91], v[44:45], v[44:45]
    v_pk_add_f32 v[88:89], v[88:89], v[48:49]
    v_pk_add_f32 v[88:89], v[88:89], v[50:51]
    v_pk_add_f32 v[88:89], v[88:89], v[52:53]
    v_pk_add_f32 v[88:89], v[88:89], v[54:55]
    v_pk_fma_f32 v[90:91], v[46:47], v[46:47], v[90:91]
    v_pk_fma_f32 v[90:91], v[48:49], v[48:49], v[90:91]
    v_pk_fma_f32 v[90:91], v[50:51], v[50:51], v[90:91]
    v_pk_fma_f32 v[90:91], v[52:53], v[52:53], v[90:91]
    v_pk_fma_f32 v[90:91], v[54:55], v[54:55], v[90:91]
    v_add_f32 v102, v88, v89
    v_add_f32 v103, v90, v91
    s_nop 1
    v_permlane32_swap_b32 v96, v100
    v_permlane32_swap_b32 v98, v102
    s_nop 0
    v_add_f32 v96, v96, v100
    v_add_f32 v98, v98, v102
    s_nop 1
    v_permlane16_swap_b32 v96, v98
    s_nop 0
    v_add_f32 v96, v96, v98
    s_nop 1
    v_permlane32_swap_b32 v97, v101
    v_permlane32_swap_b32 v99, v103
    s_nop 0
    v_add_f32 v97, v97, v101
    v_add_f32 v99, v99, v103
    s_nop 1
    v_permlane16_swap_b32 v97, v99
    s_nop 0
    v_add_f32 v97, v97, v99
    s_lshl_b32 s3, s63, 10
    s_add_u32 s3, s3, 35328
    s_lshl_b32 s46, s64, 9
    s_add_u32 s3, s3, s46
    v_add_u32 v93, s63, v2
    v_and_b32 v93, 3, v93
    v_lshl_add_u32 v93, v93, 4, v3
    v_lshlrev_b32 v93, 3, v93
    v_add_u32 v93, s3, v93
    ds_write_b64 v93, v[96:97]
    v_cvt_pk_bf16_f32 v124, v8, v9
    v_cvt_pk_bf16_f32 v125, v10, v11
    v_cvt_pk_bf16_f32 v126, v12, v13
    v_cvt_pk_bf16_f32 v127, v14, v15
    v_cvt_pk_bf16_f32 v128, v16, v17
    v_cvt_pk_bf16_f32 v129, v18, v19
    s_nop 1
    v_mfma_f32_16x16x16_bf16 v[8:11], v[124:125], v[84:85], 0
    v_mfma_f32_16x16x16_bf16 v[12:15], v[126:127], v[84:85], 0
    v_mfma_f32_16x16x16_bf16 v[16:19], v[128:129], v[84:85], 0
    v_cvt_pk_bf16_f32 v124, v20, v21
    v_cvt_pk_bf16_f32 v125, v22, v23
    v_cvt_pk_bf16_f32 v126, v24, v25
    v_cvt_pk_bf16_f32 v127, v26, v27
    v_cvt_pk_bf16_f32 v128, v28, v29
    v_cvt_pk_bf16_f32 v129, v30, v31
    s_nop 1
    v_mfma_f32_16x16x16_bf16 v[20:23], v[124:125], v[84:85], 0
    v_mfma_f32_16x16x16_bf16 v[24:27], v[126:127], v[84:85], 0
    v_mfma_f32_16x16x16_bf16 v[28:31], v[128:129], v[84:85], 0
    v_cvt_pk_bf16_f32 v124, v32, v33
    v_cvt_pk_bf16_f32 v125, v34, v35
    v_cvt_pk_bf16_f32 v126, v36, v37
    v_cvt_pk_bf16_f32 v127, v38, v39
    v_cvt_pk_bf16_f32 v128, v40, v41
    v_cvt_pk_bf16_f32 v129, v42, v43
    s_nop 1
    v_mfma_f32_16x16x16_bf16 v[32:35], v[124:125], v[84:85], 0
    v_mfma_f32_16x16x16_bf16 v[36:39], v[126:127], v[84:85], 0
    v_mfma_f32_16x16x16_bf16 v[40:43], v[128:129], v[84:85], 0
    v_cvt_pk_bf16_f32 v124, v44, v45
    v_cvt_pk_bf16_f32 v125, v46, v47
    v_cvt_pk_bf16_f32 v126, v48, v49
    v_cvt_pk_bf16_f32 v127, v50, v51
    v_cvt_pk_bf16_f32 v128, v52, v53
    v_cvt_pk_bf16_f32 v129, v54, v55
    s_nop 1
    v_mfma_f32_16x16x16_bf16 v[44:47], v[124:125], v[84:85], 0
    v_mfma_f32_16x16x16_bf16 v[48:51], v[126:127], v[84:85], 0
    v_mfma_f32_16x16x16_bf16 v[52:55], v[128:129], v[84:85], 0
    s_waitcnt lgkmcnt(0)
    s_barrier
    s_cmp_eq_u32 s64, 0
    s_cbranch_scc0 L_k1_z2s
    v_lshlrev_b32 v93, 2, v0
    v_add_u32 v94, 35328, v93
    ds_read_b32 v88, v94 offset:0
    ds_read_b32 v89, v94 offset:1024
    ds_read_b32 v90, v94 offset:2048
    ds_read_b32 v91, v94 offset:3072
    s_lshl_b32 s3, s55, 14
    s_lshl_b32 s46, s49, 3
    s_add_u32 s3, s3, s46
    s_waitcnt lgkmcnt(0)
    v_add_f32 v88, v88, v89
    v_add_f32 v90, v90, v91
    v_add_f32 v88, v88, v90
    buffer_store_dword v88, v93, s[32:35], s3 offen
L_k1_z2s:
    v_add_u32 v94, s52, v3
    v_lshlrev_b32 v94, 12, v94
    v_lshrrev_b32 v93, 1, v2
    v_lshl_add_u32 v94, v93, 4, v94
    s_lshl_b32 s46, s64, 6
    s_add_u32 s46, s46, s49
    s_lshl_b32 s46, s46, 1
    v_add_u32 v94, s46, v94
    v_and_b32 v93, 1, v2
    v_add_u32 v93, s63, v93
    v_add_u32 v92, 0, v93
    v_and_b32 v92, 3, v92
    v_lshl_add_u32 v104, v92, 5, v94
    v_add_u32 v92, 2, v93
    v_and_b32 v92, 3, v92
    v_lshl_add_u32 v105, v92, 5, v94
    s_mov_b32 s3, 0
    v_cvt_pk_bf16_f32 v8, v8, v9
    v_cvt_pk_bf16_f32 v9, v10, v11
    v_cvt_pk_bf16_f32 v10, v20, v21
    v_cvt_pk_bf16_f32 v11, v22, v23
    v_cvt_pk_bf16_f32 v32, v32, v33
    v_cvt_pk_bf16_f32 v33, v34, v35
    v_cvt_pk_bf16_f32 v34, v44, v45
    v_cvt_pk_bf16_f32 v35, v46, v47
    s_nop 1
    v_permlane16_swap_b32 v8, v10
    v_permlane16_swap_b32 v9, v11
    v_permlane16_swap_b32 v32, v34
    v_permlane16_swap_b32 v33, v35
    s_nop 0
    buffer_store_dwordx4 v[8:11], v104, s[28:31], s3 offen
    buffer_store_dwordx4 v[32:35], v105, s[28:31], s3 offen
    s_mov_b32 s3, 262144
    v_cvt_pk_bf16_f32 v12, v12, v13
    v_cvt_pk_bf16_f32 v13, v14, v15
    v_cvt_pk_bf16_f32 v14, v24, v25
    v_cvt_pk_bf16_f32 v15, v26, v27
    v_cvt_pk_bf16_f32 v36, v36, v37
    v_cvt_pk_bf16_f32 v37, v38, v39
    v_cvt_pk_bf16_f32 v38, v48, v49
    v_cvt_pk_bf16_f32 v39, v50, v51
    s_nop 1
    v_permlane16_swap_b32 v12, v14
    v_permlane16_swap_b32 v13, v15
    v_permlane16_swap_b32 v36, v38
    v_permlane16_swap_b32 v37, v39
    s_nop 0
    buffer_store_dwordx4 v[12:15], v104, s[28:31], s3 offen
    buffer_store_dwordx4 v[36:39], v105, s[28:31], s3 offen
    s_cmp_ge_u32 s63, s62
    s_cbranch_scc1 L_k1_end
    s_mov_b32 s3, 524288
    v_cvt_pk_bf16_f32 v16, v16, v17
    v_cvt_pk_bf16_f32 v17, v18, v19
    v_cvt_pk_bf16_f32 v18, v28, v29
    v_cvt_pk_bf16_f32 v19, v30, v31
    v_cvt_pk_bf16_f32 v40, v40, v41
    v_cvt_pk_bf16_f32 v41, v42, v43
    v_cvt_pk_bf16_f32 v42, v52, v53
    v_cvt_pk_bf16_f32 v43, v54, v55
    s_nop 1
    v_permlane16_swap_b32 v16, v18
    v_permlane16_swap_b32 v17, v19
    v_permlane16_swap_b32 v40, v42
    v_permlane16_swap_b32 v41, v43
    s_nop 0
    buffer_store_dwordx4 v[16:19], v104, s[28:31], s3 offen
    buffer_store_dwordx4 v[40:43], v105, s[28:31], s3 offen
L_k1_end:
    s_endpgm
.globl k2_kernel
.p2align 8
.type k2_kernel,@function
k2_kernel:
    s_cmp_ge_u32 s2, 128
    s_cbranch_scc1 L_k2_end
    s_load_dwordx2 s[12:13], s[0:1], 88
L_k2_ln:
    s_mov_b32 s40, s2
    s_and_b32 s41, s40, 7
    s_lshr_b32 s42, s40, 3
    v_and_b32 v1, 31, v0
    v_lshrrev_b32 v2, 5, v0
    s_waitcnt lgkmcnt(0)
    s_add_u32 s16, s12, 16777216
    s_addc_u32 s17, s13, 0
    s_mov_b32 s18, 65536
    s_mov_b32 s19, 0x00020000
    s_add_u32 s20, s12, 8388608
    s_addc_u32 s21, s13, 0
    s_mov_b32 s22, 2818048
    s_mov_b32 s23, 0x00020000
    s_add_u32 s24, s12, 12582912
    s_addc_u32 s25, s13, 0
    s_mov_b32 s26, 2818048
    s_mov_b32 s27, 0x00020000
    v_lshlrev_b32 v3, 6, v1
    s_lshl_b32 s43, s41, 11
    buffer_load_dwordx4 v[8:11], v3, s[16:19], s43 offen offset:0
    buffer_load_dwordx4 v[12:15], v3, s[16:19], s43 offen offset:16
    buffer_load_dwordx4 v[16:19], v3, s[16:19], s43 offen offset:32
    buffer_load_dwordx4 v[20:23], v3, s[16:19], s43 offen offset:48
    s_add_u32 s43, s43, 16384
    buffer_load_dwordx4 v[24:27], v3, s[16:19], s43 offen offset:0
    buffer_load_dwordx4 v[28:31], v3, s[16:19], s43 offen offset:16
    buffer_load_dwordx4 v[32:35], v3, s[16:19], s43 offen offset:32
    buffer_load_dwordx4 v[36:39], v3, s[16:19], s43 offen offset:48
    s_add_u32 s43, s43, 16384
    buffer_load_dwordx4 v[40:43], v3, s[16:19], s43 offen offset:0
    buffer_load_dwordx4 v[44:47], v3, s[16:19], s43 offen offset:16
    buffer_load_dwordx4 v[48:51], v3, s[16:19], s43 offen offset:32
    buffer_load_dwordx4 v[52:55], v3, s[16:19], s43 offen offset:48
    s_add_u32 s43, s43, 16384
    buffer_load_dwordx4 v[56:59], v3, s[16:19], s43 offen offset:0
    buffer_load_dwordx4 v[60:63], v3, s[16:19], s43 offen offset:16
    buffer_load_dwordx4 v[64:67], v3, s[16:19], s43 offen offset:32
    buffer_load_dwordx4 v[68:71], v3, s[16:19], s43 offen offset:48
    s_add_u32 s43, s43, 16384
    s_mul_i32 s42, s42, 43
    v_add_u32 v3, s42, v2
    v_lshlrev_b32 v3, 12, v3
    v_lshl_add_u32 v3, v1, 4, v3
    s_lshl_b32 s43, s41, 9
    v_add_u32 v96, 0, v3
    v_add_u32 v97, 32768, v3
    v_add_u32 v98, 65536, v3
    v_add_u32 v99, 98304, v3
    v_add_u32 v100, 131072, v3
    v_add_u32 v101, 163840, v3
    v_cmp_gt_u32 vcc, 3, v2
    v_mov_b32 v4, 0x7f000000
    s_nop 0
    v_cndmask_b32 v101, v4, v101, vcc
    buffer_load_dwordx4 v[72:75], v96, s[20:23], s43 offen
    buffer_load_dwordx4 v[76:79], v97, s[20:23], s43 offen
    buffer_load_dwordx4 v[80:83], v98, s[20:23], s43 offen
    buffer_load_dwordx4 v[84:87], v99, s[20:23], s43 offen
    buffer_load_dwordx4 v[88:91], v100, s[20:23], s43 offen
    buffer_load_dwordx4 v[92:95], v101, s[20:23], s43 offen
    s_waitcnt vmcnt(6)
    s_mov_b32 s44, 985563898
    v_add_f32 v8, v8, v24
    v_add_f32 v40, v40, v56
    v_add_f32 v8, v8, v40
    v_mul_f32 v8, s44, v8
    v_add_f32 v9, v9, v25
    v_add_f32 v41, v41, v57
    v_add_f32 v9, v9, v41
    v_mul_f32 v9, s44, v9
    v_add_f32 v10, v10, v26
    v_add_f32 v42, v42, v58
    v_add_f32 v10, v10, v42
    v_mul_f32 v10, s44, v10
    v_add_f32 v11, v11, v27
    v_add_f32 v43, v43, v59
    v_add_f32 v11, v11, v43
    v_mul_f32 v11, s44, v11
    v_add_f32 v12, v12, v28
    v_add_f32 v44, v44, v60
    v_add_f32 v12, v12, v44
    v_mul_f32 v12, s44, v12
    v_add_f32 v13, v13, v29
    v_add_f32 v45, v45, v61
    v_add_f32 v13, v13, v45
    v_mul_f32 v13, s44, v13
    v_add_f32 v14, v14, v30
    v_add_f32 v46, v46, v62
    v_add_f32 v14, v14, v46
    v_mul_f32 v14, s44, v14
    v_add_f32 v15, v15, v31
    v_add_f32 v47, v47, v63
    v_add_f32 v15, v15, v47
    v_mul_f32 v15, s44, v15
    v_add_f32 v16, v16, v32
    v_add_f32 v48, v48, v64
    v_add_f32 v16, v16, v48
    v_mul_f32 v16, s44, v16
    v_add_f32 v17, v17, v33
    v_add_f32 v49, v49, v65
    v_add_f32 v17, v17, v49
    v_mul_f32 v17, s44, v17
    v_add_f32 v18, v18, v34
    v_add_f32 v50, v50, v66
    v_add_f32 v18, v18, v50
    v_mul_f32 v18, s44, v18
    v_add_f32 v19, v19, v35
    v_add_f32 v51, v51, v67
    v_add_f32 v19, v19, v51
    v_mul_f32 v19, s44, v19
    v_add_f32 v20, v20, v36
    v_add_f32 v52, v52, v68
    v_add_f32 v20, v20, v52
    v_mul_f32 v20, s44, v20
    v_add_f32 v21, v21, v37
    v_add_f32 v53, v53, v69
    v_add_f32 v21, v21, v53
    v_mul_f32 v21, s44, v21
    v_add_f32 v22, v22, v38
    v_add_f32 v54, v54, v70
    v_add_f32 v22, v22, v54
    v_mul_f32 v22, s44, v22
    v_add_f32 v23, v23, v39
    v_add_f32 v55, v55, v71
    v_add_f32 v23, v23, v55
    v_mul_f32 v23, s44, v23
    v_fma_f32 v9, -v8, v8, v9
    v_max_f32 v9, 0, v9
    v_add_f32 v9, 925353388, v9
    v_rsq_f32 v9, v9
    s_nop 0
    v_mul_f32 v8, v8, v9
    v_fma_f32 v11, -v10, v10, v11
    v_max_f32 v11, 0, v11
    v_add_f32 v11, 925353388, v11
    v_rsq_f32 v11, v11
    s_nop 0
    v_mul_f32 v10, v10, v11
    v_fma_f32 v13, -v12, v12, v13
    v_max_f32 v13, 0, v13
    v_add_f32 v13, 925353388, v13
    v_rsq_f32 v13, v13
    s_nop 0
    v_mul_f32 v12, v12, v13
    v_fma_f32 v15, -v14, v14, v15
    v_max_f32 v15, 0, v15
    v_add_f32 v15, 925353388, v15
    v_rsq_f32 v15, v15
    s_nop 0
    v_mul_f32 v14, v14, v15
    v_fma_f32 v17, -v16, v16, v17
    v_max_f32 v17, 0, v17
    v_add_f32 v17, 925353388, v17
    v_rsq_f32 v17, v17
    s_nop 0
    v_mul_f32 v16, v16, v17
    v_fma_f32 v19, -v18, v18, v19
    v_max_f32 v19, 0, v19
    v_add_f32 v19, 925353388, v19
    v_rsq_f32 v19, v19
    s_nop 0
    v_mul_f32 v18, v18, v19
    v_fma_f32 v21, -v20, v20, v21
    v_max_f32 v21, 0, v21
    v_add_f32 v21, 925353388, v21
    v_rsq_f32 v21, v21
    s_nop 0
    v_mul_f32 v20, v20, v21
    v_fma_f32 v23, -v22, v22, v23
    v_max_f32 v23, 0, v23
    v_add_f32 v23, 925353388, v23
    v_rsq_f32 v23, v23
    s_nop 0
    v_mul_f32 v22, v22, v23
    s_waitcnt vmcnt(5)
    v_lshlrev_b32 v102, 16, v72
    v_and_b32 v103, 0xffff0000, v72
    v_lshlrev_b32 v104, 16, v73
    v_and_b32 v105, 0xffff0000, v73
    v_lshlrev_b32 v106, 16, v74
    v_and_b32 v107, 0xffff0000, v74
    v_lshlrev_b32 v108, 16, v75
    v_and_b32 v109, 0xffff0000, v75
    v_fma_f32 v102, v102, v9, -v8
    v_fma_f32 v103, v103, v11, -v10
    v_fma_f32 v104, v104, v13, -v12
    v_fma_f32 v105, v105, v15, -v14
    v_fma_f32 v106, v106, v17, -v16
    v_fma_f32 v107, v107, v19, -v18
    v_fma_f32 v108, v108, v21, -v20
    v_fma_f32 v109, v109, v23, -v22
    v_cvt_pk_bf16_f32 v72, v102, v103
    v_cvt_pk_bf16_f32 v73, v104, v105
    v_cvt_pk_bf16_f32 v74, v106, v107
    v_cvt_pk_bf16_f32 v75, v108, v109
    buffer_store_dwordx4 v[72:75], v96, s[24:27], s43 offen
    s_waitcnt vmcnt(5)
    v_lshlrev_b32 v102, 16, v76
    v_and_b32 v103, 0xffff0000, v76
    v_lshlrev_b32 v104, 16, v77
    v_and_b32 v105, 0xffff0000, v77
    v_lshlrev_b32 v106, 16, v78
    v_and_b32 v107, 0xffff0000, v78
    v_lshlrev_b32 v108, 16, v79
    v_and_b32 v109, 0xffff0000, v79
    v_fma_f32 v102, v102, v9, -v8
    v_fma_f32 v103, v103, v11, -v10
    v_fma_f32 v104, v104, v13, -v12
    v_fma_f32 v105, v105, v15, -v14
    v_fma_f32 v106, v106, v17, -v16
    v_fma_f32 v107, v107, v19, -v18
    v_fma_f32 v108, v108, v21, -v20
    v_fma_f32 v109, v109, v23, -v22
    v_cvt_pk_bf16_f32 v76, v102, v103
    v_cvt_pk_bf16_f32 v77, v104, v105
    v_cvt_pk_bf16_f32 v78, v106, v107
    v_cvt_pk_bf16_f32 v79, v108, v109
    buffer_store_dwordx4 v[76:79], v97, s[24:27], s43 offen
    s_waitcnt vmcnt(5)
    v_lshlrev_b32 v102, 16, v80
    v_and_b32 v103, 0xffff0000, v80
    v_lshlrev_b32 v104, 16, v81
    v_and_b32 v105, 0xffff0000, v81
    v_lshlrev_b32 v106, 16, v82
    v_and_b32 v107, 0xffff0000, v82
    v_lshlrev_b32 v108, 16, v83
    v_and_b32 v109, 0xffff0000, v83
    v_fma_f32 v102, v102, v9, -v8
    v_fma_f32 v103, v103, v11, -v10
    v_fma_f32 v104, v104, v13, -v12
    v_fma_f32 v105, v105, v15, -v14
    v_fma_f32 v106, v106, v17, -v16
    v_fma_f32 v107, v107, v19, -v18
    v_fma_f32 v108, v108, v21, -v20
    v_fma_f32 v109, v109, v23, -v22
    v_cvt_pk_bf16_f32 v80, v102, v103
    v_cvt_pk_bf16_f32 v81, v104, v105
    v_cvt_pk_bf16_f32 v82, v106, v107
    v_cvt_pk_bf16_f32 v83, v108, v109
    buffer_store_dwordx4 v[80:83], v98, s[24:27], s43 offen
    s_waitcnt vmcnt(5)
    v_lshlrev_b32 v102, 16, v84
    v_and_b32 v103, 0xffff0000, v84
    v_lshlrev_b32 v104, 16, v85
    v_and_b32 v105, 0xffff0000, v85
    v_lshlrev_b32 v106, 16, v86
    v_and_b32 v107, 0xffff0000, v86
    v_lshlrev_b32 v108, 16, v87
    v_and_b32 v109, 0xffff0000, v87
    v_fma_f32 v102, v102, v9, -v8
    v_fma_f32 v103, v103, v11, -v10
    v_fma_f32 v104, v104, v13, -v12
    v_fma_f32 v105, v105, v15, -v14
    v_fma_f32 v106, v106, v17, -v16
    v_fma_f32 v107, v107, v19, -v18
    v_fma_f32 v108, v108, v21, -v20
    v_fma_f32 v109, v109, v23, -v22
    v_cvt_pk_bf16_f32 v84, v102, v103
    v_cvt_pk_bf16_f32 v85, v104, v105
    v_cvt_pk_bf16_f32 v86, v106, v107
    v_cvt_pk_bf16_f32 v87, v108, v109
    buffer_store_dwordx4 v[84:87], v99, s[24:27], s43 offen
    s_waitcnt vmcnt(5)
    v_lshlrev_b32 v102, 16, v88
    v_and_b32 v103, 0xffff0000, v88
    v_lshlrev_b32 v104, 16, v89
    v_and_b32 v105, 0xffff0000, v89
    v_lshlrev_b32 v106, 16, v90
    v_and_b32 v107, 0xffff0000, v90
    v_lshlrev_b32 v108, 16, v91
    v_and_b32 v109, 0xffff0000, v91
    v_fma_f32 v102, v102, v9, -v8
    v_fma_f32 v103, v103, v11, -v10
    v_fma_f32 v104, v104, v13, -v12
    v_fma_f32 v105, v105, v15, -v14
    v_fma_f32 v106, v106, v17, -v16
    v_fma_f32 v107, v107, v19, -v18
    v_fma_f32 v108, v108, v21, -v20
    v_fma_f32 v109, v109, v23, -v22
    v_cvt_pk_bf16_f32 v88, v102, v103
    v_cvt_pk_bf16_f32 v89, v104, v105
    v_cvt_pk_bf16_f32 v90, v106, v107
    v_cvt_pk_bf16_f32 v91, v108, v109
    buffer_store_dwordx4 v[88:91], v100, s[24:27], s43 offen
    s_waitcnt vmcnt(5)
    v_lshlrev_b32 v102, 16, v92
    v_and_b32 v103, 0xffff0000, v92
    v_lshlrev_b32 v104, 16, v93
    v_and_b32 v105, 0xffff0000, v93
    v_lshlrev_b32 v106, 16, v94
    v_and_b32 v107, 0xffff0000, v94
    v_lshlrev_b32 v108, 16, v95
    v_and_b32 v109, 0xffff0000, v95
    v_fma_f32 v102, v102, v9, -v8
    v_fma_f32 v103, v103, v11, -v10
    v_fma_f32 v104, v104, v13, -v12
    v_fma_f32 v105, v105, v15, -v14
    v_fma_f32 v106, v106, v17, -v16
    v_fma_f32 v107, v107, v19, -v18
    v_fma_f32 v108, v108, v21, -v20
    v_fma_f32 v109, v109, v23, -v22
    v_cvt_pk_bf16_f32 v92, v102, v103
    v_cvt_pk_bf16_f32 v93, v104, v105
    v_cvt_pk_bf16_f32 v94, v106, v107
    v_cvt_pk_bf16_f32 v95, v108, v109
    buffer_store_dwordx4 v[92:95], v101, s[24:27], s43 offen
L_k2_end:
    s_endpgm
.globl k3_kernel
.p2align 8
.type k3_kernel,@function
k3_kernel:
    s_cmp_ge_u32 s2, 256
    s_cbranch_scc1 L_k3_o
    s_load_dwordx2 s[4:5], s[0:1], 48
    s_load_dwordx2 s[6:7], s[0:1], 56
    s_load_dwordx2 s[12:13], s[0:1], 88
    v_and_b32 v1, 63, v0
    v_lshrrev_b32 v4, 6, v0
    v_lshrrev_b32 v2, 4, v1
    v_readfirstlane_b32 s40, v4
    v_and_b32 v3, 15, v1
    s_and_b32 s3, s2, 7
    s_lshl_b32 s3, s3, 2
    s_lshr_b32 s47, s2, 6
    s_add_u32 s47, s47, s3
    s_lshl_b32 s47, s47, 6
    s_bfe_u32 s48, s2, 0x30003
    s_mul_i32 s49, s48, 96
    s_mul_i32 s3, s48, 80
    s_add_u32 s3, s3, 64
    s_min_u32 s49, s49, s3
    s_and_b32 s50, s40, 1
    s_lshl_b32 s50, s50, 5
    s_lshr_b32 s51, s40, 1
    s_mul_i32 s51, s51, 48
    s_waitcnt lgkmcnt(0)
    s_cmp_lt_u32 s40, 4
    s_cbranch_scc1 L_k3_c
    s_sub_u32 s40, s40, 4
    s_mov_b32 s16, s4
    s_mov_b32 s17, s5
    s_mov_b32 s18, 8388608
    s_mov_b32 s19, 0x00020000
    s_add_u32 s20, s12, 12582912
    s_addc_u32 s21, s13, 0
    s_mov_b32 s22, 2818048
    s_mov_b32 s23, 0x00020000
    s_and_b32 s46, s40, 1
    s_lshl_b32 s46, s46, 2
    v_add_u32 v4, s46, v2
    v_and_b32 v5, 7, v1
    v_xor_b32 v4, v4, v5
    v_lshlrev_b32 v4, 4, v4
    s_lshl_b32 s46, s40, 3
    s_add_u32 s46, s46, s47
    v_lshrrev_b32 v5, 3, v1
    v_add_u32 v5, s46, v5
    s_mov_b32 s46, 4096
    v_mad_u32_u24 v8, v5, s46, v4
    v_add_u32 v9, 131072, v8
    s_and_b32 s46, s40, 1
    s_lshl_b32 s46, s46, 2
    v_add_u32 v4, s46, v2
    v_and_b32 v5, 7, v1
    v_xor_b32 v4, v4, v5
    v_lshlrev_b32 v4, 4, v4
    s_lshl_b32 s46, s40, 3
    s_add_u32 s46, s46, s49
    v_lshrrev_b32 v5, 3, v1
    v_add_u32 v5, s46, v5
    s_mov_b32 s46, 4096
    v_mad_u32_u24 v10, v5, s46, v4
    v_add_u32 v11, 131072, v10
    v_add_u32 v12, 262144, v10
    s_mov_b32 s43, 0
    s_lshl_b32 s42, s40, 10
    s_add_u32 s41, s42, 81920
    s_mov_b32 s45, 0
L_k3_lpro:
    s_add_u32 m0, s42, 0
    s_nop 0
    buffer_load_dwordx4 v8, s[16:19], s43 offen lds
    s_add_u32 m0, s42, 4096
    s_nop 0
    buffer_load_dwordx4 v9, s[16:19], s43 offen lds
    s_add_u32 m0, s42, 8192
    s_nop 0
    buffer_load_dwordx4 v10, s[20:23], s43 offen lds
    s_add_u32 m0, s42, 12288
    s_nop 0
    buffer_load_dwordx4 v11, s[20:23], s43 offen lds
    s_add_u32 m0, s42, 16384
    s_nop 0
    buffer_load_dwordx4 v12, s[20:23], s43 offen lds
    s_add_u32 s45, s45, 1
    s_add_u32 s43, s43, 128
    s_add_u32 s42, s42, 20480
    s_cmp_eq_u32 s42, s41
    s_cselect_b32 s46, 81920, 0
    s_sub_u32 s42, s42, s46
    s_cmp_lg_u32 s45, 2
    s_cbranch_scc1 L_k3_lpr2
    s_waitcnt vmcnt(5)
    s_barrier
L_k3_lpr2:
    s_cmp_lt_u32 s45, 4
    s_cbranch_scc1 L_k3_lpro
L_k3_lloop:
    s_waitcnt vmcnt(10)
    s_barrier
    s_add_u32 m0, s42, 0
    s_nop 0
    buffer_load_dwordx4 v8, s[16:19], s43 offen lds
    s_add_u32 m0, s42, 4096
    s_nop 0
    buffer_load_dwordx4 v9, s[16:19], s43 offen lds
    s_add_u32 m0, s42, 8192
    s_nop 0
    buffer_load_dwordx4 v10, s[20:23], s43 offen lds
    s_add_u32 m0, s42, 12288
    s_nop 0
    buffer_load_dwordx4 v11, s[20:23], s43 offen lds
    s_add_u32 m0, s42, 16384
    s_nop 0
    buffer_load_dwordx4 v12, s[20:23], s43 offen lds
    s_add_u32 s45, s45, 1
    s_add_u32 s43, s43, 128
    s_add_u32 s42, s42, 20480
    s_cmp_eq_u32 s42, s41
    s_cselect_b32 s46, 81920, 0
    s_sub_u32 s42, s42, s46
    s_cmp_lt_u32 s45, 32
    s_cbranch_scc1 L_k3_lloop
    s_waitcnt vmcnt(10)
    s_barrier
    s_waitcnt vmcnt(5)
    s_barrier
    s_waitcnt vmcnt(0)
    s_barrier
    s_barrier
    s_endpgm
L_k3_c:
    s_add_u32 s24, s12, 4194304
    s_addc_u32 s25, s13, 0
    s_mov_b32 s26, 2883584
    s_mov_b32 s27, 0x00020000
    s_mov_b32 s28, s6
    s_mov_b32 s29, s7
    s_mov_b32 s30, 4096
    s_mov_b32 s31, 0x00020000
    s_add_u32 s32, s12, 20971520
    s_addc_u32 s33, s13, 0
    s_mov_b32 s34, 4980736
    s_mov_b32 s35, 0x00020000
    s_add_u32 s3, s47, s50
    v_add_u32 v4, s3, v3
    v_lshlrev_b32 v5, 1, v4
    buffer_load_ushort v44, v5, s[28:31], 0 offen
    buffer_load_ushort v45, v5, s[28:31], 0 offen offset:32
    s_add_u32 s3, s49, s51
    s_lshl_b32 s3, s3, 1
    v_lshrrev_b32 v5, 1, v2
    v_lshlrev_b32 v5, 4, v5
    v_add_u32 v5, s3, v5
    v_and_b32 v6, 1, v2
    v_lshl_add_u32 v4, v6, 4, v4
    s_mov_b32 s3, 1408
    v_mad_u32_u24 v6, v4, s3, v5
    s_mov_b32 s3, 2432
    v_mad_u32_u24 v46, v4, s3, v5
    buffer_load_dwordx4 v[32:35], v6, s[24:27], 0 offen offset:0
    buffer_load_dwordx4 v[36:39], v6, s[24:27], 0 offen offset:32
    buffer_load_dwordx4 v[40:43], v6, s[24:27], 0 offen offset:64
    v_lshrrev_b32 v4, 1, v3
    v_xor_b32 v4, v4, v2
    v_lshlrev_b32 v4, 4, v4
    v_lshl_add_u32 v4, v3, 7, v4
    v_xor_b32 v5, 64, v4
    s_lshl_b32 s46, s50, 7
    v_add_u32 v88, s46, v4
    v_add_u32 v89, s46, v5
    s_lshl_b32 s46, s51, 7
    s_add_u32 s46, s46, 8192
    v_add_u32 v92, s46, v4
    v_add_u32 v93, s46, v5
    v_mov_b32 v8, 0
    v_mov_b32 v9, 0
    v_mov_b32 v10, 0
    v_mov_b32 v11, 0
    v_mov_b32 v12, 0
    v_mov_b32 v13, 0
    v_mov_b32 v14, 0
    v_mov_b32 v15, 0
    v_mov_b32 v16, 0
    v_mov_b32 v17, 0
    v_mov_b32 v18, 0
    v_mov_b32 v19, 0
    v_mov_b32 v20, 0
    v_mov_b32 v21, 0
    v_mov_b32 v22, 0
    v_mov_b32 v23, 0
    v_mov_b32 v24, 0
    v_mov_b32 v25, 0
    v_mov_b32 v26, 0
    v_mov_b32 v27, 0
    v_mov_b32 v28, 0
    v_mov_b32 v29, 0
    v_mov_b32 v30, 0
    v_mov_b32 v31, 0
    s_mov_b32 s45, 0
    s_mov_b32 s41, 0
    v_add_u32 v90, s41, v88
    v_add_u32 v91, s41, v89
    v_add_u32 v94, s41, v92
    v_add_u32 v95, s41, v93
    s_barrier
    ds_read_b128 v[64:67], v94 offset:0
    ds_read_b128 v[68:71], v94 offset:2048
    ds_read_b128 v[72:75], v94 offset:4096
    ds_read_b128 v[48:51], v90 offset:0
    ds_read_b128 v[52:55], v90 offset:2048
L_k3_loop:
    s_waitcnt lgkmcnt(0)
    v_mfma_f32_16x16x32_bf16 v[8:11], v[64:67], v[48:51], v[8:11]
    ds_read_b128 v[76:79], v95 offset:0
    ds_read_b128 v[80:83], v95 offset:2048
    ds_read_b128 v[84:87], v95 offset:4096
    v_mfma_f32_16x16x32_bf16 v[12:15], v[68:71], v[48:51], v[12:15]
    ds_read_b128 v[56:59], v91 offset:0
    ds_read_b128 v[60:63], v91 offset:2048
    s_add_u32 s41, s41, 20480
    v_mfma_f32_16x16x32_bf16 v[16:19], v[72:75], v[48:51], v[16:19]
    s_cmp_eq_u32 s41, 81920
    s_cselect_b32 s41, 0, s41
    s_add_u32 s45, s45, 1
    v_mfma_f32_16x16x32_bf16 v[20:23], v[64:67], v[52:55], v[20:23]
    v_add_u32 v90, s41, v88
    v_add_u32 v91, s41, v89
    v_add_u32 v94, s41, v92
    v_mfma_f32_16x16x32_bf16 v[24:27], v[68:71], v[52:55], v[24:27]
    v_add_u32 v95, s41, v93
    v_mfma_f32_16x16x32_bf16 v[28:31], v[72:75], v[52:55], v[28:31]
    s_waitcnt lgkmcnt(0)
    s_barrier
    v_mfma_f32_16x16x32_bf16 v[8:11], v[76:79], v[56:59], v[8:11]
    ds_read_b128 v[64:67], v94 offset:0
    v_mfma_f32_16x16x32_bf16 v[12:15], v[80:83], v[56:59], v[12:15]
    ds_read_b128 v[68:71], v94 offset:2048
    v_mfma_f32_16x16x32_bf16 v[16:19], v[84:87], v[56:59], v[16:19]
    ds_read_b128 v[72:75], v94 offset:4096
    v_mfma_f32_16x16x32_bf16 v[20:23], v[76:79], v[60:63], v[20:23]
    ds_read_b128 v[48:51], v90 offset:0
    v_mfma_f32_16x16x32_bf16 v[24:27], v[80:83], v[60:63], v[24:27]
    ds_read_b128 v[52:55], v90 offset:2048
    v_mfma_f32_16x16x32_bf16 v[28:31], v[84:87], v[60:63], v[28:31]
L_k3_hback:
    s_cmp_lt_u32 s45, 32
    s_cbranch_scc1 L_k3_loop
    s_waitcnt lgkmcnt(0)
    s_nop 7
    s_waitcnt vmcnt(0)
    v_permlane16_swap_b32 v32, v34
    v_permlane16_swap_b32 v33, v35
    v_permlane16_swap_b32 v36, v38
    v_permlane16_swap_b32 v37, v39
    v_permlane16_swap_b32 v40, v42
    v_permlane16_swap_b32 v41, v43
    s_add_u32 s3, s49, s51
    s_cmp_eq_u32 s3, 672
    s_cbranch_scc0 L_k3_np
    v_mov_b32 v36, 0
    v_mov_b32 v37, 0
    v_mov_b32 v38, 0
    v_mov_b32 v39, 0
L_k3_np:
    v_lshlrev_b32 v44, 16, v44
    v_lshlrev_b32 v45, 16, v45
    v_lshlrev_b32 v4, 16, v32
    v_and_b32 v5, 0xffff0000, v32
    v_lshlrev_b32 v6, 16, v33
    v_and_b32 v7, 0xffff0000, v33
    v_add_f32 v8, v44, v8
    v_add_f32 v9, v44, v9
    v_add_f32 v10, v44, v10
    v_add_f32 v11, v44, v11
    v_mul_f32 v8, v4, v8
    v_mul_f32 v9, v5, v9
    v_mul_f32 v10, v6, v10
    v_mul_f32 v11, v7, v11
    v_lshlrev_b32 v4, 16, v34
    v_and_b32 v5, 0xffff0000, v34
    v_lshlrev_b32 v6, 16, v35
    v_and_b32 v7, 0xffff0000, v35
    v_add_f32 v20, v45, v20
    v_add_f32 v21, v45, v21
    v_add_f32 v22, v45, v22
    v_add_f32 v23, v45, v23
    v_mul_f32 v20, v4, v20
    v_mul_f32 v21, v5, v21
    v_mul_f32 v22, v6, v22
    v_mul_f32 v23, v7, v23
    v_cvt_pk_bf16_f32 v8, v8, v9
    v_cvt_pk_bf16_f32 v9, v10, v11
    v_cvt_pk_bf16_f32 v10, v20, v21
    v_cvt_pk_bf16_f32 v11, v22, v23
    s_nop 1
    v_permlane16_swap_b32 v8, v10
    v_permlane16_swap_b32 v9, v11
    s_nop 0
    buffer_store_dwordx4 v[8:11], v46, s[32:35], 0 offen offset:1024
    v_lshlrev_b32 v4, 16, v36
    v_and_b32 v5, 0xffff0000, v36
    v_lshlrev_b32 v6, 16, v37
    v_and_b32 v7, 0xffff0000, v37
    v_add_f32 v12, v44, v12
    v_add_f32 v13, v44, v13
    v_add_f32 v14, v44, v14
    v_add_f32 v15, v44, v15
    v_mul_f32 v12, v4, v12
    v_mul_f32 v13, v5, v13
    v_mul_f32 v14, v6, v14
    v_mul_f32 v15, v7, v15
    v_lshlrev_b32 v4, 16, v38
    v_and_b32 v5, 0xffff0000, v38
    v_lshlrev_b32 v6, 16, v39
    v_and_b32 v7, 0xffff0000, v39
    v_add_f32 v24, v45, v24
    v_add_f32 v25, v45, v25
    v_add_f32 v26, v45, v26
    v_add_f32 v27, v45, v27
    v_mul_f32 v24, v4, v24
    v_mul_f32 v25, v5, v25
    v_mul_f32 v26, v6, v26
    v_mul_f32 v27, v7, v27
    v_cvt_pk_bf16_f32 v12, v12, v13
    v_cvt_pk_bf16_f32 v13, v14, v15
    v_cvt_pk_bf16_f32 v14, v24, v25
    v_cvt_pk_bf16_f32 v15, v26, v27
    s_nop 1
    v_permlane16_swap_b32 v12, v14
    v_permlane16_swap_b32 v13, v15
    s_nop 0
    buffer_store_dwordx4 v[12:15], v46, s[32:35], 0 offen offset:1056
    s_lshr_b32 s3, s48, 2
    s_lshr_b32 s46, s40, 1
    s_and_b32 s3, s3, s46
    s_cbranch_scc1 L_k3_end
    v_lshlrev_b32 v4, 16, v40
    v_and_b32 v5, 0xffff0000, v40
    v_lshlrev_b32 v6, 16, v41
    v_and_b32 v7, 0xffff0000, v41
    v_add_f32 v16, v44, v16
    v_add_f32 v17, v44, v17
    v_add_f32 v18, v44, v18
    v_add_f32 v19, v44, v19
    v_mul_f32 v16, v4, v16
    v_mul_f32 v17, v5, v17
    v_mul_f32 v18, v6, v18
    v_mul_f32 v19, v7, v19
    v_lshlrev_b32 v4, 16, v42
    v_and_b32 v5, 0xffff0000, v42
    v_lshlrev_b32 v6, 16, v43
    v_and_b32 v7, 0xffff0000, v43
    v_add_f32 v28, v45, v28
    v_add_f32 v29, v45, v29
    v_add_f32 v30, v45, v30
    v_add_f32 v31, v45, v31
    v_mul_f32 v28, v4, v28
    v_mul_f32 v29, v5, v29
    v_mul_f32 v30, v6, v30
    v_mul_f32 v31, v7, v31
    v_cvt_pk_bf16_f32 v16, v16, v17
    v_cvt_pk_bf16_f32 v17, v18, v19
    v_cvt_pk_bf16_f32 v18, v28, v29
    v_cvt_pk_bf16_f32 v19, v30, v31
    s_nop 1
    v_permlane16_swap_b32 v16, v18
    v_permlane16_swap_b32 v17, v19
    s_nop 0
    buffer_store_dwordx4 v[16:19], v46, s[32:35], 0 offen offset:1088
L_k3_end:
    s_endpgm
L_k3_o:
    s_cmp_ge_u32 s2, 512
    s_cbranch_scc1 L_k3_end
    v_lshrrev_b32 v1, 8, v0
    s_nop 0
    v_readfirstlane_b32 s3, v1
    s_nop 3
    s_cmp_lg_u32 s3, 0
    s_cbranch_scc1 L_k3_end
    s_load_dwordx2 s[12:13], s[0:1], 88
    s_sub_u32 s44, s2, 256
    v_and_b32 v1, 63, v0
    v_lshrrev_b32 v4, 6, v0
    v_lshrrev_b32 v2, 4, v1
    v_readfirstlane_b32 s40, v4
    v_and_b32 v3, 15, v1
    s_waitcnt lgkmcnt(0)
    s_add_u32 s24, s12, 20971520
    s_addc_u32 s25, s13, 0
    s_mov_b32 s26, 4980736
    s_mov_b32 s27, 0x00020000
    s_add_u32 s16, s12, 17825792
    s_addc_u32 s17, s13, 0
    s_mov_b32 s18, 2097152
    s_mov_b32 s19, 0x00020000
    s_mov_b32 s20, s12
    s_mov_b32 s21, s13
    s_mov_b32 s22, 4194304
    s_mov_b32 s23, 0x00020000
    s_and_b32 s42, s44, 7
    s_lshl_b32 s42, s42, 2
    s_bfe_u32 s3, s44, 0x20003
    s_add_u32 s42, s42, s3
    s_lshl_b32 s3, s40, 18
    s_lshl_b32 s41, s42, 11
    s_add_u32 s3, s3, s41
    v_lshlrev_b32 v4, 5, v1
    buffer_load_dwordx4 v[8:11], v4, s[16:19], s3 offen
    buffer_load_dwordx4 v[12:15], v4, s[16:19], s3 offen offset:16
    s_add_u32 s3, s3, 65536
    buffer_load_dwordx4 v[16:19], v4, s[16:19], s3 offen
    buffer_load_dwordx4 v[20:23], v4, s[16:19], s3 offen offset:16
    s_add_u32 s3, s3, 65536
    buffer_load_dwordx4 v[24:27], v4, s[16:19], s3 offen
    buffer_load_dwordx4 v[28:31], v4, s[16:19], s3 offen offset:16
    s_add_u32 s3, s3, 65536
    buffer_load_dwordx4 v[32:35], v4, s[16:19], s3 offen
    buffer_load_dwordx4 v[36:39], v4, s[16:19], s3 offen offset:16
    v_lshlrev_b32 v5, 12, v3
    v_lshl_add_u32 v5, v2, 5, v5
    s_lshl_b32 s3, s42, 7
    s_add_u32 s3, s3, 1048576
    buffer_load_dwordx4 v[40:43], v5, s[16:19], s3 offen
    buffer_load_dwordx4 v[44:47], v5, s[16:19], s3 offen offset:16
    s_lshr_b32 s3, s44, 5
    s_lshl_b32 s3, s3, 2
    s_add_u32 s3, s3, s40
    s_lshl_b32 s3, s3, 6
    v_add_u32 v6, s3, v3
    v_lshlrev_b32 v5, 11, v6
    v_lshl_add_u32 v5, v2, 4, v5
    s_lshl_b32 s3, s42, 6
    buffer_load_dwordx4 v[56:59], v5, s[20:23], s3 offen
    s_add_u32 s3, s3, 32768
    buffer_load_dwordx4 v[60:63], v5, s[20:23], s3 offen
    s_add_u32 s3, s3, 32768
    buffer_load_dwordx4 v[64:67], v5, s[20:23], s3 offen
    s_add_u32 s3, s3, 32768
    buffer_load_dwordx4 v[68:71], v5, s[20:23], s3 offen
    s_mov_b32 s3, 2432
    v_lshrrev_b32 v5, 1, v2
    v_lshlrev_b32 v5, 4, v5
    v_and_b32 v4, 1, v2
    v_lshl_add_u32 v6, v4, 4, v6
    v_mad_u32_u24 v72, v6, s3, v5
    v_lshlrev_b32 v73, 4, v1
    v_add_u32 v73, 0, v73
    s_lshl_b32 s3, s40, 11
    v_add_u32 v4, s3, v73
    s_waitcnt vmcnt(6)
    v_add_f32 v8, v8, v16
    v_add_f32 v24, v24, v32
    v_add_f32 v9, v9, v17
    v_add_f32 v25, v25, v33
    v_add_f32 v10, v10, v18
    v_add_f32 v26, v26, v34
    v_add_f32 v11, v11, v19
    v_add_f32 v27, v27, v35
    v_add_f32 v12, v12, v20
    v_add_f32 v28, v28, v36
    v_add_f32 v13, v13, v21
    v_add_f32 v29, v29, v37
    v_add_f32 v14, v14, v22
    v_add_f32 v30, v30, v38
    v_add_f32 v15, v15, v23
    v_add_f32 v31, v31, v39
    v_add_f32 v8, v8, v24
    v_add_f32 v9, v9, v25
    v_add_f32 v10, v10, v26
    v_add_f32 v11, v11, v27
    v_add_f32 v12, v12, v28
    v_add_f32 v13, v13, v29
    v_add_f32 v14, v14, v30
    v_add_f32 v15, v15, v31
    ds_write_b128 v4, v[8:11]
    ds_write_b128 v4, v[12:15] offset:1024
    s_waitcnt vmcnt(4)
    v_add_f32_dpp v40, v40, v40 row_ror:8 row_mask:0xf bank_mask:0xf
    v_add_f32_dpp v41, v41, v41 row_ror:8 row_mask:0xf bank_mask:0xf
    v_add_f32_dpp v42, v42, v42 row_ror:8 row_mask:0xf bank_mask:0xf
    v_add_f32_dpp v43, v43, v43 row_ror:8 row_mask:0xf bank_mask:0xf
    v_add_f32_dpp v44, v44, v44 row_ror:8 row_mask:0xf bank_mask:0xf
    v_add_f32_dpp v45, v45, v45 row_ror:8 row_mask:0xf bank_mask:0xf
    v_add_f32_dpp v46, v46, v46 row_ror:8 row_mask:0xf bank_mask:0xf
    v_add_f32_dpp v47, v47, v47 row_ror:8 row_mask:0xf bank_mask:0xf
    v_add_f32_dpp v40, v40, v40 row_ror:4 row_mask:0xf bank_mask:0xf
    v_add_f32_dpp v41, v41, v41 row_ror:4 row_mask:0xf bank_mask:0xf
    v_add_f32_dpp v42, v42, v42 row_ror:4 row_mask:0xf bank_mask:0xf
    v_add_f32_dpp v43, v43, v43 row_ror:4 row_mask:0xf bank_mask:0xf
    v_add_f32_dpp v44, v44, v44 row_ror:4 row_mask:0xf bank_mask:0xf
    v_add_f32_dpp v45, v45, v45 row_ror:4 row_mask:0xf bank_mask:0xf
    v_add_f32_dpp v46, v46, v46 row_ror:4 row_mask:0xf bank_mask:0xf
    v_add_f32_dpp v47, v47, v47 row_ror:4 row_mask:0xf bank_mask:0xf
    v_add_f32_dpp v40, v40, v40 row_ror:2 row_mask:0xf bank_mask:0xf
    v_add_f32_dpp v41, v41, v41 row_ror:2 row_mask:0xf bank_mask:0xf
    v_add_f32_dpp v42, v42, v42 row_ror:2 row_mask:0xf bank_mask:0xf
    v_add_f32_dpp v43, v43, v43 row_ror:2 row_mask:0xf bank_mask:0xf
    v_add_f32_dpp v44, v44, v44 row_ror:2 row_mask:0xf bank_mask:0xf
    v_add_f32_dpp v45, v45, v45 row_ror:2 row_mask:0xf bank_mask:0xf
    v_add_f32_dpp v46, v46, v46 row_ror:2 row_mask:0xf bank_mask:0xf
    v_add_f32_dpp v47, v47, v47 row_ror:2 row_mask:0xf bank_mask:0xf
    v_add_f32_dpp v40, v40, v40 row_ror:1 row_mask:0xf bank_mask:0xf
    v_add_f32_dpp v41, v41, v41 row_ror:1 row_mask:0xf bank_mask:0xf
    v_add_f32_dpp v42, v42, v42 row_ror:1 row_mask:0xf bank_mask:0xf
    v_add_f32_dpp v43, v43, v43 row_ror:1 row_mask:0xf bank_mask:0xf
    v_add_f32_dpp v44, v44, v44 row_ror:1 row_mask:0xf bank_mask:0xf
    v_add_f32_dpp v45, v45, v45 row_ror:1 row_mask:0xf bank_mask:0xf
    v_add_f32_dpp v46, v46, v46 row_ror:1 row_mask:0xf bank_mask:0xf
    v_add_f32_dpp v47, v47, v47 row_ror:1 row_mask:0xf bank_mask:0xf
    v_cvt_pk_bf16_f32 v52, v40, v41
    v_cvt_pk_bf16_f32 v53, v42, v43
    v_cvt_pk_bf16_f32 v54, v44, v45
    v_cvt_pk_bf16_f32 v55, v46, v47
    s_waitcnt lgkmcnt(0)
    s_barrier
    ds_read_b128 v[8:11], v73 offset:0
    ds_read_b128 v[12:15], v73 offset:1024
    ds_read_b128 v[16:19], v73 offset:2048
    ds_read_b128 v[20:23], v73 offset:3072
    ds_read_b128 v[24:27], v73 offset:4096
    ds_read_b128 v[28:31], v73 offset:5120
    ds_read_b128 v[32:35], v73 offset:6144
    ds_read_b128 v[36:39], v73 offset:7168
    s_waitcnt lgkmcnt(0)
    v_add_f32 v8, v8, v16
    v_add_f32 v24, v24, v32
    v_add_f32 v9, v9, v17
    v_add_f32 v25, v25, v33
    v_add_f32 v10, v10, v18
    v_add_f32 v26, v26, v34
    v_add_f32 v11, v11, v19
    v_add_f32 v27, v27, v35
    v_add_f32 v12, v12, v20
    v_add_f32 v28, v28, v36
    v_add_f32 v13, v13, v21
    v_add_f32 v29, v29, v37
    v_add_f32 v14, v14, v22
    v_add_f32 v30, v30, v38
    v_add_f32 v15, v15, v23
    v_add_f32 v31, v31, v39
    v_add_f32 v8, v8, v24
    v_add_f32 v9, v9, v25
    v_add_f32 v10, v10, v26
    v_add_f32 v11, v11, v27
    v_add_f32 v12, v12, v28
    v_add_f32 v13, v13, v29
    v_add_f32 v14, v14, v30
    v_add_f32 v15, v15, v31
    v_cvt_pk_bf16_f32 v48, v8, v9
    v_cvt_pk_bf16_f32 v49, v10, v11
    v_cvt_pk_bf16_f32 v50, v12, v13
    v_cvt_pk_bf16_f32 v51, v14, v15
    s_lshl_b32 s3, s42, 5
    s_waitcnt vmcnt(0)
    v_mfma_f32_16x16x32_bf16 v[8:11], v[48:51], v[56:59], 0
    v_mfma_f32_16x16x32_bf16 v[12:15], v[52:55], v[56:59], 0
    v_mfma_f32_16x16x32_bf16 v[16:19], v[48:51], v[60:63], 0
    v_mfma_f32_16x16x32_bf16 v[20:23], v[52:55], v[60:63], 0
    v_mfma_f32_16x16x32_bf16 v[24:27], v[48:51], v[64:67], 0
    v_mfma_f32_16x16x32_bf16 v[28:31], v[52:55], v[64:67], 0
    v_mfma_f32_16x16x32_bf16 v[32:35], v[48:51], v[68:71], 0
    v_mfma_f32_16x16x32_bf16 v[36:39], v[52:55], v[68:71], 0
    s_nop 7
    v_add_f32 v12, 897988541, v12
    v_add_f32 v20, 897988541, v20
    v_add_f32 v28, 897988541, v28
    v_add_f32 v36, 897988541, v36
    v_rcp_f32 v12, v12
    v_rcp_f32 v20, v20
    v_rcp_f32 v28, v28
    v_rcp_f32 v36, v36
    v_mul_f32 v8, v12, v8
    v_mul_f32 v9, v12, v9
    v_mul_f32 v10, v12, v10
    v_mul_f32 v11, v12, v11
    v_mul_f32 v16, v20, v16
    v_mul_f32 v17, v20, v17
    v_mul_f32 v18, v20, v18
    v_mul_f32 v19, v20, v19
    v_mul_f32 v24, v28, v24
    v_mul_f32 v25, v28, v25
    v_mul_f32 v26, v28, v26
    v_mul_f32 v27, v28, v27
    v_mul_f32 v32, v36, v32
    v_mul_f32 v33, v36, v33
    v_mul_f32 v34, v36, v34
    v_mul_f32 v35, v36, v35
    s_add_u32 s41, s3, 77824
    v_cvt_pk_bf16_f32 v8, v8, v9
    v_cvt_pk_bf16_f32 v9, v10, v11
    v_cvt_pk_bf16_f32 v10, v16, v17
    v_cvt_pk_bf16_f32 v11, v18, v19
    v_cvt_pk_bf16_f32 v24, v24, v25
    v_cvt_pk_bf16_f32 v25, v26, v27
    v_cvt_pk_bf16_f32 v26, v32, v33
    v_cvt_pk_bf16_f32 v27, v34, v35
    s_nop 1
    v_permlane16_swap_b32 v8, v10
    v_permlane16_swap_b32 v9, v11
    v_permlane16_swap_b32 v24, v26
    v_permlane16_swap_b32 v25, v27
    s_nop 0
    buffer_store_dwordx4 v[8:11], v72, s[24:27], s3 offen
    buffer_store_dwordx4 v[24:27], v72, s[24:27], s41 offen
    s_endpgm
.globl k4_kernel
.p2align 8
.type k4_kernel,@function
k4_kernel:
    s_cmp_ge_u32 s2, 256
    s_cbranch_scc1 L_k4_end
    s_load_dwordx2 s[4:5], s[0:1], 0
    s_load_dwordx2 s[6:7], s[0:1], 24
    s_load_dwordx2 s[8:9], s[0:1], 64
    s_load_dwordx2 s[10:11], s[0:1], 72
    s_load_dwordx2 s[12:13], s[0:1], 88
    v_and_b32 v1, 63, v0
    v_lshrrev_b32 v4, 6, v0
    v_lshrrev_b32 v2, 4, v1
    v_readfirstlane_b32 s40, v4
    v_and_b32 v3, 15, v1
    s_and_b32 s3, s2, 7
    s_lshl_b32 s3, s3, 2
    s_lshr_b32 s47, s2, 6
    s_add_u32 s47, s47, s3
    s_lshl_b32 s47, s47, 6
    s_bfe_u32 s48, s2, 0x30003
    s_and_b32 s49, s40, 1
    s_lshl_b32 s49, s49, 5
    s_and_b32 s50, s40, 2
    s_mov_b32 s51, 1024
    s_mov_b32 s52, 0
    s_lshl_b32 s53, s48, 7
    s_waitcnt lgkmcnt(0)
    s_cmp_lt_u32 s40, 4
    s_cbranch_scc1 L_k4_c
    s_sub_u32 s40, s40, 4
    s_add_u32 s16, s12, 20971520
    s_addc_u32 s17, s13, 0
    s_mov_b32 s18, 4980736
    s_mov_b32 s19, 0x00020000
    s_mov_b32 s20, s6
    s_mov_b32 s21, s7
    s_mov_b32 s22, 524288
    s_mov_b32 s23, 0x00020000
    s_and_b32 s46, s40, 1
    s_lshl_b32 s46, s46, 2
    v_add_u32 v4, s46, v2
    v_and_b32 v5, 7, v1
    v_xor_b32 v4, v4, v5
    v_lshlrev_b32 v4, 4, v4
    s_lshl_b32 s46, s40, 3
    s_add_u32 s46, s46, s47
    v_lshrrev_b32 v5, 3, v1
    v_add_u32 v5, s46, v5
    s_mov_b32 s46, 2432
    v_mad_u32_u24 v8, v5, s46, v4
    v_add_u32 v9, 77824, v8
    s_lshl_b32 s46, s40, 6
    s_add_u32 s46, s46, 0
    v_add_u32 v4, s46, v1
    v_lshrrev_b32 v5, 3, v4
    v_and_b32 v4, 7, v4
    v_and_b32 v6, 2, v5
    v_lshrrev_b32 v7, 1, v5
    v_and_b32 v7, 4, v7
    v_or_b32 v6, v6, v7
    v_xor_b32 v4, v4, v6
    v_lshrrev_b32 v6, 3, v4
    v_mul_lo_u32 v6, v6, s52
    v_lshl_add_u32 v4, v4, 4, v6
    v_mul_lo_u32 v5, v5, s51
    v_add3_u32 v10, v4, v5, s53
    s_lshl_b32 s46, s40, 6
    s_add_u32 s46, s46, 256
    v_add_u32 v4, s46, v1
    v_lshrrev_b32 v5, 3, v4
    v_and_b32 v4, 7, v4
    v_and_b32 v6, 2, v5
    v_lshrrev_b32 v7, 1, v5
    v_and_b32 v7, 4, v7
    v_or_b32 v6, v6, v7
    v_xor_b32 v4, v4, v6
    v_lshrrev_b32 v6, 3, v4
    v_mul_lo_u32 v6, v6, s52
    v_lshl_add_u32 v4, v4, 4, v6
    v_mul_lo_u32 v5, v5, s51
    v_add3_u32 v11, v4, v5, s53
    s_mov_b32 s43, 0
    s_mov_b32 s44, 0
    s_lshl_b32 s42, s40, 10
    s_add_u32 s41, s42, 98304
    s_mov_b32 s45, 0
L_k4_lpro:
    s_add_u32 m0, s42, 0
    s_nop 0
    buffer_load_dwordx4 v8, s[16:19], s43 offen lds
    s_add_u32 m0, s42, 4096
    s_nop 0
    buffer_load_dwordx4 v9, s[16:19], s43 offen lds
    s_add_u32 m0, s42, 8192
    s_nop 0
    buffer_load_dwordx4 v10, s[20:23], s44 offen lds
    s_add_u32 m0, s42, 12288
    s_nop 0
    buffer_load_dwordx4 v11, s[20:23], s44 offen lds
    s_add_u32 s45, s45, 1
    s_add_u32 s43, s43, 128
    s_add_u32 s44, s44, 65536
    s_cmp_eq_u32 s45, 8
    s_cselect_b32 s20, s8, s20
    s_cselect_b32 s21, s9, s21
    s_cselect_b32 s22, 704512, s22
    s_cselect_b32 s44, 0, s44
    s_add_u32 s42, s42, 16384
    s_cmp_eq_u32 s42, s41
    s_cselect_b32 s46, 98304, 0
    s_sub_u32 s42, s42, s46
    s_cmp_lg_u32 s45, 2
    s_cbranch_scc1 L_k4_lpr2
    s_waitcnt vmcnt(4)
    s_barrier
L_k4_lpr2:
    s_cmp_lt_u32 s45, 6
    s_cbranch_scc1 L_k4_lpro
L_k4_lloop:
    s_waitcnt vmcnt(16)
    s_barrier
    s_add_u32 m0, s42, 0
    s_nop 0
    buffer_load_dwordx4 v8, s[16:19], s43 offen lds
    s_add_u32 m0, s42, 4096
    s_nop 0
    buffer_load_dwordx4 v9, s[16:19], s43 offen lds
    s_add_u32 m0, s42, 8192
    s_nop 0
    buffer_load_dwordx4 v10, s[20:23], s44 offen lds
    s_add_u32 m0, s42, 12288
    s_nop 0
    buffer_load_dwordx4 v11, s[20:23], s44 offen lds
    s_add_u32 s45, s45, 1
    s_add_u32 s43, s43, 128
    s_add_u32 s44, s44, 65536
    s_cmp_eq_u32 s45, 8
    s_cselect_b32 s20, s8, s20
    s_cselect_b32 s21, s9, s21
    s_cselect_b32 s22, 704512, s22
    s_cselect_b32 s44, 0, s44
    s_add_u32 s42, s42, 16384
    s_cmp_eq_u32 s42, s41
    s_cselect_b32 s46, 98304, 0
    s_sub_u32 s42, s42, s46
    s_cmp_lt_u32 s45, 19
    s_cbranch_scc1 L_k4_lloop
    s_waitcnt vmcnt(16)
    s_barrier
    s_waitcnt vmcnt(12)
    s_barrier
    s_waitcnt vmcnt(8)
    s_barrier
    s_waitcnt vmcnt(4)
    s_barrier
    s_waitcnt vmcnt(0)
    s_barrier
    s_barrier
    s_endpgm
L_k4_c:
    s_mov_b32 s24, s4
    s_mov_b32 s25, s5
    s_mov_b32 s26, 2097152
    s_mov_b32 s27, 0x00020000
    s_mov_b32 s28, s10
    s_mov_b32 s29, s11
    s_mov_b32 s30, 2097152
    s_mov_b32 s31, 0x00020000
    s_add_u32 s3, s47, s49
    v_add_u32 v4, s3, v3
    v_and_b32 v5, 1, v2
    v_lshl_add_u32 v4, v5, 4, v4
    v_lshlrev_b32 v4, 10, v4
    s_lshl_b32 s3, s50, 5
    s_add_u32 s3, s3, s53
    v_lshrrev_b32 v5, 1, v2
    v_lshl_add_u32 v4, v5, 4, v4
    v_add_u32 v32, s3, v4
    buffer_load_dwordx4 v[24:27], v32, s[24:27], 0 offen offset:0
    buffer_load_dwordx4 v[28:31], v32, s[24:27], 0 offen offset:32
    v_lshrrev_b32 v4, 1, v3
    v_xor_b32 v4, v4, v2
    v_lshlrev_b32 v4, 4, v4
    v_lshl_add_u32 v4, v3, 7, v4
    v_xor_b32 v5, 64, v4
    s_lshl_b32 s46, s49, 7
    v_add_u32 v68, s46, v4
    v_add_u32 v69, s46, v5
    v_lshrrev_b32 v4, 2, v3
    v_lshl_add_u32 v4, v2, 3, v4
    v_mul_u32_u24 v4, 128, v4
    v_and_b32 v5, 3, v3
    v_lshl_add_u32 v4, v5, 3, v4
    v_add_u32 v4, 8192, v4
    v_lshrrev_b32 v5, 3, v3
    v_and_b32 v6, 1, v2
    v_lshl_or_b32 v5, v6, 1, v5
    s_add_u32 s46, s50, 0
    v_xor_b32 v6, s46, v5
    v_lshl_add_u32 v72, v6, 5, v4
    s_add_u32 s46, s50, 1
    v_xor_b32 v6, s46, v5
    v_lshl_add_u32 v73, v6, 5, v4
    v_mov_b32 v8, 0
    v_mov_b32 v9, 0
    v_mov_b32 v10, 0
    v_mov_b32 v11, 0
    v_mov_b32 v12, 0
    v_mov_b32 v13, 0
    v_mov_b32 v14, 0
    v_mov_b32 v15, 0
    v_mov_b32 v16, 0
    v_mov_b32 v17, 0
    v_mov_b32 v18, 0
    v_mov_b32 v19, 0
    v_mov_b32 v20, 0
    v_mov_b32 v21, 0
    v_mov_b32 v22, 0
    v_mov_b32 v23, 0
    s_mov_b32 s45, 0
    s_mov_b32 s41, 0
    v_add_u32 v70, s41, v68
    v_add_u32 v71, s41, v69
    v_add_u32 v74, s41, v72
    v_add_u32 v75, s41, v73
    s_barrier
    ds_read_b64_tr_b16 v[52:53], v74 offset:0
    ds_read_b64_tr_b16 v[54:55], v74 offset:512
    ds_read_b64_tr_b16 v[56:57], v75 offset:0
    ds_read_b64_tr_b16 v[58:59], v75 offset:512
    ds_read_b128 v[36:39], v70 offset:0
    ds_read_b128 v[40:43], v70 offset:2048
L_k4_loop:
    s_waitcnt lgkmcnt(0)
    v_mfma_f32_16x16x32_bf16 v[8:11], v[52:55], v[36:39], v[8:11]
    ds_read_b64_tr_b16 v[60:61], v74 offset:4096
    ds_read_b64_tr_b16 v[62:63], v74 offset:4608
    ds_read_b64_tr_b16 v[64:65], v75 offset:4096
    ds_read_b64_tr_b16 v[66:67], v75 offset:4608
    v_mfma_f32_16x16x32_bf16 v[12:15], v[56:59], v[36:39], v[12:15]
    ds_read_b128 v[44:47], v71 offset:0
    ds_read_b128 v[48:51], v71 offset:2048
    s_add_u32 s41, s41, 16384
    s_cmp_eq_u32 s41, 98304
    v_mfma_f32_16x16x32_bf16 v[16:19], v[52:55], v[40:43], v[16:19]
    s_cselect_b32 s41, 0, s41
    s_add_u32 s45, s45, 1
    v_add_u32 v70, s41, v68
    v_add_u32 v71, s41, v69
    v_mfma_f32_16x16x32_bf16 v[20:23], v[56:59], v[40:43], v[20:23]
    v_add_u32 v74, s41, v72
    v_add_u32 v75, s41, v73
    s_waitcnt lgkmcnt(0)
    s_barrier
    v_mfma_f32_16x16x32_bf16 v[8:11], v[60:63], v[44:47], v[8:11]
    ds_read_b64_tr_b16 v[52:53], v74 offset:0
    ds_read_b64_tr_b16 v[54:55], v74 offset:512
    v_mfma_f32_16x16x32_bf16 v[12:15], v[64:67], v[44:47], v[12:15]
    ds_read_b64_tr_b16 v[56:57], v75 offset:0
    ds_read_b64_tr_b16 v[58:59], v75 offset:512
    v_mfma_f32_16x16x32_bf16 v[16:19], v[60:63], v[48:51], v[16:19]
    ds_read_b128 v[36:39], v70 offset:0
    ds_read_b128 v[40:43], v70 offset:2048
    v_mfma_f32_16x16x32_bf16 v[20:23], v[64:67], v[48:51], v[20:23]
L_k4_hback:
    s_cmp_lt_u32 s45, 19
    s_cbranch_scc1 L_k4_loop
    s_waitcnt lgkmcnt(0)
    s_nop 7
    s_waitcnt vmcnt(0)
    v_permlane16_swap_b32 v24, v26
    v_permlane16_swap_b32 v25, v27
    v_permlane16_swap_b32 v28, v30
    v_permlane16_swap_b32 v29, v31
    s_nop 0
    v_lshlrev_b32 v4, 16, v24
    v_and_b32 v5, 0xffff0000, v24
    v_lshlrev_b32 v6, 16, v25
    v_and_b32 v7, 0xffff0000, v25
    v_add_f32 v8, v4, v8
    v_add_f32 v9, v5, v9
    v_add_f32 v10, v6, v10
    v_add_f32 v11, v7, v11
    v_lshlrev_b32 v4, 16, v26
    v_and_b32 v5, 0xffff0000, v26
    v_lshlrev_b32 v6, 16, v27
    v_and_b32 v7, 0xffff0000, v27
    v_add_f32 v16, v4, v16
    v_add_f32 v17, v5, v17
    v_add_f32 v18, v6, v18
    v_add_f32 v19, v7, v19
    v_lshlrev_b32 v4, 16, v28
    v_and_b32 v5, 0xffff0000, v28
    v_lshlrev_b32 v6, 16, v29
    v_and_b32 v7, 0xffff0000, v29
    v_add_f32 v12, v4, v12
    v_add_f32 v13, v5, v13
    v_add_f32 v14, v6, v14
    v_add_f32 v15, v7, v15
    v_lshlrev_b32 v4, 16, v30
    v_and_b32 v5, 0xffff0000, v30
    v_lshlrev_b32 v6, 16, v31
    v_and_b32 v7, 0xffff0000, v31
    v_add_f32 v20, v4, v20
    v_add_f32 v21, v5, v21
    v_add_f32 v22, v6, v22
    v_add_f32 v23, v7, v23
    v_cvt_pk_bf16_f32 v8, v8, v9
    v_cvt_pk_bf16_f32 v9, v10, v11
    v_cvt_pk_bf16_f32 v10, v16, v17
    v_cvt_pk_bf16_f32 v11, v18, v19
    v_cvt_pk_bf16_f32 v12, v12, v13
    v_cvt_pk_bf16_f32 v13, v14, v15
    v_cvt_pk_bf16_f32 v14, v20, v21
    v_cvt_pk_bf16_f32 v15, v22, v23
    s_nop 1
    v_permlane16_swap_b32 v8, v10
    v_permlane16_swap_b32 v9, v11
    v_permlane16_swap_b32 v12, v14
    v_permlane16_swap_b32 v13, v15
    s_nop 0
    buffer_store_dwordx4 v[8:11], v32, s[28:31], 0 offen offset:0
    buffer_store_dwordx4 v[12:15], v32, s[28:31], 0 offen offset:32
L_k4_end:
    s_endpgm
L_text_end:
.section .rodata,"a"
.p2align 6
.amdhsa_kernel k1_kernel
  .amdhsa_next_free_vgpr 168
  .amdhsa_next_free_sgpr 102
  .amdhsa_accum_offset 168
  .amdhsa_group_segment_fixed_size 0
  .amdhsa_kernarg_size 96
  .amdhsa_user_sgpr_count 2
  .amdhsa_user_sgpr_kernarg_segment_ptr 1
  .amdhsa_system_sgpr_workgroup_id_x 1
.end_amdhsa_kernel
.p2align 6
.amdhsa_kernel k2_kernel
  .amdhsa_next_free_vgpr 112
  .amdhsa_next_free_sgpr 102
  .amdhsa_accum_offset 112
  .amdhsa_group_segment_fixed_size 0
  .amdhsa_kernarg_size 96
  .amdhsa_user_sgpr_count 2
  .amdhsa_user_sgpr_kernarg_segment_ptr 1
  .amdhsa_system_sgpr_workgroup_id_x 1
.end_amdhsa_kernel
.p2align 6
.amdhsa_kernel k3_kernel
  .amdhsa_next_free_vgpr 96
  .amdhsa_next_free_sgpr 102
  .amdhsa_accum_offset 96
  .amdhsa_group_segment_fixed_size 0
  .amdhsa_kernarg_size 96
  .amdhsa_user_sgpr_count 2
  .amdhsa_user_sgpr_kernarg_segment_ptr 1
  .amdhsa_system_sgpr_workgroup_id_x 1
.end_amdhsa_kernel
.p2align 6
.amdhsa_kernel k4_kernel
  .amdhsa_next_free_vgpr 80
  .amdhsa_next_free_sgpr 102
  .amdhsa_accum_offset 80
  .amdhsa_group_segment_fixed_size 0
  .amdhsa_kernarg_size 96
  .amdhsa_user_sgpr_count 2
  .amdhsa_user_sgpr_kernarg_segment_ptr 1
  .amdhsa_system_sgpr_workgroup_id_x 1
.end_amdhsa_kernel
```
